```python
import torch

def _softmax(x, axis=-1):
    return torch.softmax(x, dim=axis)
def _gelu(x):
    return torch.nn.functional.gelu(x, approximate="tanh")
def _silu(x):
    return torch.nn.functional.silu(x)
def _sigmoid(x):
    return torch.sigmoid(x)
def _layernorm(x, axis=-1, eps=1e-5):
    m = x.mean(dim=axis, keepdim=True)
    v = x.var(dim=axis, keepdim=True, unbiased=False)
    return (x - m) / torch.sqrt(v + eps)
def _scatter_add(tgt, idx, src, axis=0):
    return tgt.clone().index_add_(axis, idx, src)
def _segment_sum(src, seg, n):
    out = torch.zeros((n,) + src.shape[1:], dtype=src.dtype)
    return out.index_add_(0, seg, src)
def _pad(x, pw):
    flat = tuple(v for pair in reversed(pw) for v in pair)
    return torch.nn.functional.pad(x, flat)

kernel_name = 'gather_scatter__mpnn_edge_mlp__graph'

def setup_inputs():

    _w = (lambda a: (lambda t: t.to(torch.bfloat16) if t.is_floating_point() else t)(torch.as_tensor(a)))
    N, deg, D, De = 10000, 32, 128, max(0, 1)
    E = N * deg
    return {
        "x": _w((lambda *s: torch.randn(*s, dtype=torch.bfloat16) * 0.05)(N, D)),
        "e_attr": _w((lambda *s: torch.randn(*s, dtype=torch.bfloat16) * 0.4)(E, De)),
        "src": _w((lambda lo, hi, *s: torch.randint(lo, hi, s))(0, N, E).to(torch.int64)),
        "dst": _w((lambda lo, hi, *s: torch.randint(lo, hi, s))(0, N, E).to(torch.int64)),
        "w_msg": _w((lambda *s: torch.randn(*s, dtype=torch.bfloat16) * 0.4)(2 * D + De, D)),
        "w_upd": _w((lambda *s: torch.randn(*s, dtype=torch.bfloat16) * 0.05)(2 * D, D)),
    }

def reference(x, e_attr, src, dst, w_msg, w_upd):
    N, D = x.shape
    m_in = torch.concatenate([x[src], x[dst], e_attr], axis=-1)
    msg = _silu(m_in @ w_msg)
    agg = _segment_sum(msg, dst, N)
    return _silu(torch.concatenate([x, agg], axis=-1) @ w_upd)
```

```asm
; @launch kernel=mpnn_prep_kernel grid=(260,1,1) block=(1024,1,1) lds=49152
; @launch kernel=mpnn_edge_kernel grid=(256,1,1) block=(1024,1,1) lds=159488
.amdgcn_target "amdgcn-amd-amdhsa--gfx950"
.text
.globl mpnn_prep_kernel
.p2align 8
.type mpnn_prep_kernel,@function
mpnn_prep_kernel:
    s_load_dwordx16 s[4:19], s[0:1], 0
    s_load_dwordx2 s[20:21], s[0:1], 64
    v_lshrrev_b32 v1, 6, v0
    v_and_b32 v2, 63, v0
    s_cmp_ge_u32 s2, 260
    s_cbranch_scc1 k1_end
    v_readfirstlane_b32 s3, v1
    v_lshlrev_b32 v48, 4, v0

    s_cmp_ge_u32 s2, 100
    s_cbranch_scc1 k1_w

    v_lshlrev_b32 v3, 2, v0
    v_mov_b32 v4, 0
    v_mov_b32 v5, 0
    v_mov_b32 v6, 0
    v_mov_b32 v7, 0
    ds_write_b32 v3, v4 offset:32768
    s_cmp_lt_u32 s3, 8
    s_cbranch_scc0 k1_nolz
    ds_write_b128 v48, v[4:7] offset:36864

k1_nolz:
    v_lshlrev_b32 v6, 3, v0
    s_mul_i32 s22, s2, 12800
    s_mul_i32 s23, s2, 6400
    v_cmp_gt_u32 vcc, 800, v0
    s_mov_b32 s46, 0xffff0000
    v_mov_b32 v7, 1
    s_waitcnt lgkmcnt(0)

    s_mov_b32 s24, s10
    s_and_b32 s25, s11, 0xffff
    s_mov_b32 s26, 1280000
    s_mov_b32 s27, 0x20000
    s_and_saveexec_b64 s[44:45], vcc
    buffer_load_dwordx4 v[8:11], v48, s[24:27], s22 offen

    s_mov_b32 s28, s8
    s_and_b32 s29, s9, 0xffff
    s_mov_b32 s30, 1280000
    s_mov_b32 s31, 0x20000
    buffer_load_dwordx4 v[12:15], v48, s[28:31], s22 offen
    s_mov_b32 s32, s6
    s_and_b32 s33, s7, 0xffff
    s_mov_b32 s34, 640000
    s_mov_b32 s35, 0x20000
    buffer_load_dwordx2 v[16:17], v6, s[32:35], s23 offen
    s_barrier
    s_add_u32 s36, s20, 2752512
    s_addc_u32 s37, s21, 0
    s_and_b32 s37, s37, 0xffff
    s_mov_b32 s38, 3276800
    s_mov_b32 s39, 0x20000
    s_waitcnt vmcnt(2)
    v_mul_u32_u24 v20, 429497, v8
    v_lshrrev_b32 v20, 24, v20
    v_lshlrev_b32 v36, 2, v20
    ds_add_rtn_u32 v28, v36, v7 offset:32768

    v_mul_u32_u24 v21, 429497, v9
    v_lshrrev_b32 v21, 24, v21
    v_lshlrev_b32 v37, 2, v21
    ds_add_rtn_u32 v29, v37, v7 offset:32768

    v_mul_u32_u24 v22, 429497, v10
    v_lshrrev_b32 v22, 24, v22
    v_lshlrev_b32 v38, 2, v22
    ds_add_rtn_u32 v30, v38, v7 offset:32768

    v_mul_u32_u24 v23, 429497, v11
    v_lshrrev_b32 v23, 24, v23
    v_lshlrev_b32 v39, 2, v23
    ds_add_rtn_u32 v31, v39, v7 offset:32768

    v_mul_u32_u24 v24, 625, v20
    v_add_u32 v24, 15, v24
    v_lshrrev_b32 v24, 4, v24
    v_sub_u32 v24, v8, v24
    v_add_u32 v24, 1, v24
    v_lshlrev_b32 v36, 7, v20
    v_lshlrev_b32 v40, 5, v20

    v_mul_u32_u24 v25, 625, v21
    v_add_u32 v25, 15, v25
    v_lshrrev_b32 v25, 4, v25
    v_sub_u32 v25, v9, v25
    v_add_u32 v25, 1, v25
    v_lshlrev_b32 v37, 7, v21
    v_lshlrev_b32 v41, 5, v21

    v_mul_u32_u24 v26, 625, v22
    v_add_u32 v26, 15, v26
    v_lshrrev_b32 v26, 4, v26
    v_sub_u32 v26, v10, v26
    v_add_u32 v26, 1, v26
    v_lshlrev_b32 v38, 7, v22
    v_lshlrev_b32 v42, 5, v22

    v_mul_u32_u24 v27, 625, v23
    v_add_u32 v27, 15, v27
    v_lshrrev_b32 v27, 4, v27
    v_sub_u32 v27, v11, v27
    v_add_u32 v27, 1, v27
    v_lshlrev_b32 v39, 7, v23
    v_lshlrev_b32 v43, 5, v23

    s_waitcnt vmcnt(0)
    v_lshl_or_b32 v32, v16, 16, v12
    v_and_or_b32 v33, v16, s46, v13
    v_lshl_or_b32 v34, v17, 16, v14
    v_and_or_b32 v35, v17, s46, v15
    s_waitcnt lgkmcnt(0)

    v_max3_u32 v44, v28, v29, v30
    v_max_u32 v44, v44, v31
    v_cmp_lt_u32 vcc, 31, v44
    s_cbranch_vccnz k1_ovf

    v_lshl_add_u32 v36, v28, 2, v36
    v_add_u32 v40, v28, v40
    ds_write_b32 v36, v32
    ds_write_b8 v40, v24 offset:36864

    v_lshl_add_u32 v37, v29, 2, v37
    v_add_u32 v41, v29, v41
    ds_write_b32 v37, v33
    ds_write_b8 v41, v25 offset:36864

    v_lshl_add_u32 v38, v30, 2, v38
    v_add_u32 v42, v30, v42
    ds_write_b32 v38, v34
    ds_write_b8 v42, v26 offset:36864

    v_lshl_add_u32 v39, v31, 2, v39
    v_add_u32 v43, v31, v43
    ds_write_b32 v39, v35
    ds_write_b8 v43, v27 offset:36864

k1_bin2:
    s_mov_b64 exec, s[44:45]
    v_lshrrev_b32 v6, 3, v0
    v_and_b32 v29, 7, v0
    v_mov_b32 v31, 12800
    v_mul_u32_u24 v30, v6, v31
    v_lshl_add_u32 v30, v29, 4, v30
    v_lshrrev_b32 v6, 1, v0
    v_and_b32 v29, 1, v0
    v_mov_b32 v31, 3200
    v_mul_u32_u24 v32, v6, v31
    v_lshl_add_u32 v32, v29, 4, v32
    s_lshl_b32 s22, s2, 7
    s_add_u32 s23, s22, 1638400
    s_lshl_b32 s49, s2, 5
    s_lshl_b32 s50, s2, 2
    s_waitcnt lgkmcnt(0)
    s_barrier

    ds_read_b128 v[8:11], v48
    ds_read_b128 v[12:15], v48 offset:16384
    v_lshrrev_b32 v33, 3, v0
    v_lshlrev_b32 v33, 2, v33
    ds_read_b32 v34, v33 offset:32768
    ds_read_b32 v35, v33 offset:33280
    v_and_b32 v33, 7, v0
    v_lshlrev_b32 v33, 2, v33
    s_cmp_lt_u32 s3, 8
    s_cbranch_scc0 k1_noloc
    ds_read_b128 v[24:27], v48 offset:36864
    ds_read_b32 v28, v4 offset:33792

    s_add_u32 s24, s20, 6029312
    s_addc_u32 s25, s21, 0
    s_and_b32 s25, s25, 0xffff
    s_mov_b32 s26, 819200
    s_mov_b32 s27, 0x20000
    s_add_u32 s28, s20, 6881280
    s_addc_u32 s29, s21, 0
    s_and_b32 s29, s29, 0xffff
    s_mov_b32 s30, 400
    s_mov_b32 s31, 0x20000
    s_waitcnt lgkmcnt(0)
    buffer_store_dwordx4 v[24:27], v32, s[24:27], s49 offen
    s_cmp_eq_u32 s3, 0
    s_cbranch_scc0 k1_noloc
    s_mov_b64 exec, 1
    buffer_store_dword v28, v4, s[28:31], s50 offen
    s_mov_b64 exec, -1

k1_noloc:
    s_waitcnt lgkmcnt(0)

    v_cmp_lt_u32 vcc, v33, v34
    v_cmp_lt_u32 s[52:53], v33, v35
    s_mov_b64 exec, vcc
    buffer_store_dwordx4 v[8:11], v30, s[36:39], s22 offen
    s_mov_b64 exec, s[52:53]
    buffer_store_dwordx4 v[12:15], v30, s[36:39], s23 offen

    s_endpgm
k1_ovf:
    s_add_u32 s40, s20, 8388608
    s_addc_u32 s41, s21, 0
    s_and_b32 s41, s41, 0xffff
    s_mov_b32 s42, 2560000
    s_mov_b32 s43, 0x20000
    s_mul_i32 s50, s2, 25600
    s_mov_b64 s[52:53], exec
    v_lshl_add_u32 v36, v28, 2, v36
    v_add_u32 v40, v28, v40
    v_cmp_gt_u32 vcc, 32, v28
    s_and_b64 exec, s[52:53], vcc
    ds_write_b32 v36, v32
    ds_write_b8 v40, v24 offset:36864
    s_andn2_b64 exec, s[52:53], vcc
    s_cbranch_execz k1_noovf0
    ds_add_rtn_u32 v44, v4, v7 offset:33792
    v_mov_b32 v46, v8
    v_mov_b32 v47, v32
    s_waitcnt lgkmcnt(0)
    v_lshlrev_b32 v44, 3, v44
    buffer_store_dwordx2 v[46:47], v44, s[40:43], s50 offen

k1_noovf0:
    s_mov_b64 exec, s[52:53]
    v_lshl_add_u32 v37, v29, 2, v37
    v_add_u32 v41, v29, v41
    v_cmp_gt_u32 vcc, 32, v29
    s_and_b64 exec, s[52:53], vcc
    ds_write_b32 v37, v33
    ds_write_b8 v41, v25 offset:36864
    s_andn2_b64 exec, s[52:53], vcc
    s_cbranch_execz k1_noovf1
    ds_add_rtn_u32 v44, v4, v7 offset:33792
    v_mov_b32 v46, v9
    v_mov_b32 v47, v33
    s_waitcnt lgkmcnt(0)
    v_lshlrev_b32 v44, 3, v44
    buffer_store_dwordx2 v[46:47], v44, s[40:43], s50 offen

k1_noovf1:
    s_mov_b64 exec, s[52:53]
    v_lshl_add_u32 v38, v30, 2, v38
    v_add_u32 v42, v30, v42
    v_cmp_gt_u32 vcc, 32, v30
    s_and_b64 exec, s[52:53], vcc
    ds_write_b32 v38, v34
    ds_write_b8 v42, v26 offset:36864
    s_andn2_b64 exec, s[52:53], vcc
    s_cbranch_execz k1_noovf2
    ds_add_rtn_u32 v44, v4, v7 offset:33792
    v_mov_b32 v46, v10
    v_mov_b32 v47, v34
    s_waitcnt lgkmcnt(0)
    v_lshlrev_b32 v44, 3, v44
    buffer_store_dwordx2 v[46:47], v44, s[40:43], s50 offen

k1_noovf2:
    s_mov_b64 exec, s[52:53]
    v_lshl_add_u32 v39, v31, 2, v39
    v_add_u32 v43, v31, v43
    v_cmp_gt_u32 vcc, 32, v31
    s_and_b64 exec, s[52:53], vcc
    ds_write_b32 v39, v35
    ds_write_b8 v43, v27 offset:36864
    s_andn2_b64 exec, s[52:53], vcc
    s_cbranch_execz k1_noovf3
    ds_add_rtn_u32 v44, v4, v7 offset:33792
    v_mov_b32 v46, v11
    v_mov_b32 v47, v35
    s_waitcnt lgkmcnt(0)
    v_lshlrev_b32 v44, 3, v44
    buffer_store_dwordx2 v[46:47], v44, s[40:43], s50 offen

k1_noovf3:
    s_mov_b64 exec, s[52:53]
    s_branch k1_bin2
k1_w:
    s_waitcnt lgkmcnt(0)
    s_sub_u32 s22, s2, 100
    s_sub_u32 s23, s22, 157
    s_cmp_ge_u32 s22, 157
    s_cselect_b32 s51, 1, 0
    s_cmp_ge_i32 s23, 1
    s_cselect_b32 s24, s14, s12
    s_cselect_b32 s25, s15, s13
    s_cmp_eq_u32 s23, 0
    s_cselect_b32 s46, 32768, 0
    s_cmp_eq_u32 s23, 2
    s_cselect_b32 s46, 32768, s46
    s_add_u32 s24, s24, s46
    s_addc_u32 s25, s25, 0
    s_and_b32 s25, s25, 0xffff
    s_mov_b32 s26, 32768
    s_mov_b32 s27, 0x20000
    s_mov_b32 s44, 16384
    buffer_load_dwordx4 v[4:7], v48, s[24:27], 0 offen
    buffer_load_dwordx4 v[8:11], v48, s[24:27], s44 offen

    s_mov_b32 s28, s4
    s_and_b32 s29, s5, 0xffff
    s_cmp_eq_u32 s51, 0
    s_cselect_b32 s30, 2560000, 0
    s_mov_b32 s31, 0x20000
    s_lshl_b32 s48, s22, 14
    buffer_load_dwordx4 v[16:19], v48, s[28:31], s48 offen
    v_lshrrev_b32 v12, 4, v0
    v_and_b32 v14, 3, v12
    v_bfe_u32 v15, v12, 3, 1
    v_lshl_or_b32 v14, v15, 2, v14
    v_lshlrev_b32 v14, 1, v14
    v_and_b32 v15, 15, v0
    v_xor_b32 v20, v15, v12
    v_and_b32 v20, 15, v20
    v_lshlrev_b32 v20, 4, v20
    v_lshl_add_u32 v20, v12, 8, v20
    v_xor_b32 v15, v15, v14
    v_lshlrev_b32 v15, 4, v15
    v_lshl_add_u32 v12, v12, 8, v15
    v_lshrrev_b32 v13, 4, v2
    v_bfe_u32 v14, v2, 2, 2
    v_and_b32 v15, 3, v2
    v_and_b32 v44, 1, v13
    v_lshl_or_b32 v44, v44, 2, v14
    v_lshlrev_b32 v45, 11, v13
    v_lshl_add_u32 v45, v14, 8, v45
    v_lshl_add_u32 v45, v15, 3, v45
    v_lshl_add_u32 v45, v44, 5, v45
    s_and_b32 s47, s3, 3
    v_and_b32 v21, 15, v2
    v_xor_b32 v22, v13, v21
    v_lshlrev_b32 v22, 4, v22
    v_lshl_add_u32 v22, v21, 8, v22
    s_lshl_b32 s49, s47, 12
    s_add_u32 s49, s49, 32768
    v_add_u32 v22, s49, v22
    s_lshl_b32 s47, s47, 4
    s_lshl_b32 s48, s22, 6
    s_add_u32 s47, s47, s48
    v_add_u32 v46, s47, v21
    v_lshlrev_b32 v46, 8, v46
    s_waitcnt vmcnt(1)
    ds_write_b128 v12, v[4:7]
    ds_write_b128 v12, v[8:11] offset:16384
    s_waitcnt vmcnt(0)
    ds_write_b128 v20, v[16:19] offset:32768
    s_waitcnt lgkmcnt(0)

    s_barrier
    s_cmp_eq_u32 s51, 0
    s_cbranch_scc0 k1_frag
    s_lshr_b32 s47, s3, 2
    s_lshl_b32 s48, s47, 6
    v_xor_b32 v44, s48, v45
    v_xor_b32 v45, 32, v44
    v_xor_b32 v23, 64, v22
    v_xor_b32 v12, 0x80, v22
    v_xor_b32 v14, 0xc0, v22
    ds_read_b128 v[16:19], v22
    ds_read_b128 v[24:27], v12
    ds_read_b128 v[28:31], v14
    ds_read_b128 v[20:23], v23

    ds_read_b64_tr_b16 v[48:49], v44 offset:0
    ds_read_b64_tr_b16 v[50:51], v44 offset:1024
    ds_read_b64_tr_b16 v[52:53], v44 offset:8192
    ds_read_b64_tr_b16 v[54:55], v44 offset:9216
    ds_read_b64_tr_b16 v[56:57], v44 offset:16384
    ds_read_b64_tr_b16 v[58:59], v44 offset:17408
    ds_read_b64_tr_b16 v[60:61], v44 offset:24576
    ds_read_b64_tr_b16 v[62:63], v44 offset:25600
    ds_read_b64_tr_b16 v[32:33], v45 offset:0
    ds_read_b64_tr_b16 v[34:35], v45 offset:1024
    ds_read_b64_tr_b16 v[36:37], v45 offset:8192
    ds_read_b64_tr_b16 v[38:39], v45 offset:9216
    ds_read_b64_tr_b16 v[40:41], v45 offset:16384
    ds_read_b64_tr_b16 v[42:43], v45 offset:17408
    ds_read_b64_tr_b16 v[4:5], v45 offset:24576
    ds_read_b64_tr_b16 v[6:7], v45 offset:25600
    s_mov_b32 s32, s20
    s_and_b32 s33, s21, 0xffff
    s_mov_b32 s34, 2560256
    s_mov_b32 s35, 0x20000
    v_lshl_add_u32 v47, v13, 6, v46
    s_lshl_b32 s47, s47, 4
    v_add_u32 v47, s47, v47
    s_mov_b32 s44, 0xbfb8aa3b
    s_mov_b32 s45, 0xbfb8aa3b
    s_waitcnt vmcnt(0) lgkmcnt(8)

    v_mfma_f32_16x16x32_bf16 v[8:11], v[48:51], v[16:19], 0
    v_mfma_f32_16x16x32_bf16 v[8:11], v[52:55], v[20:23], v[8:11]
    v_mfma_f32_16x16x32_bf16 v[8:11], v[56:59], v[24:27], v[8:11]
    v_mfma_f32_16x16x32_bf16 v[8:11], v[60:63], v[28:31], v[8:11]
    s_waitcnt lgkmcnt(0)
    v_mfma_f32_16x16x32_bf16 v[12:15], v[32:35], v[16:19], 0
    v_mfma_f32_16x16x32_bf16 v[12:15], v[36:39], v[20:23], v[12:15]
    v_mfma_f32_16x16x32_bf16 v[12:15], v[40:43], v[24:27], v[12:15]
    v_mfma_f32_16x16x32_bf16 v[12:15], v[4:7], v[28:31], v[12:15]
    s_nop 7
    v_pk_mul_f32 v[8:9], v[8:9], s[44:45]
    v_pk_mul_f32 v[10:11], v[10:11], s[44:45]
    v_pk_mul_f32 v[12:13], v[12:13], s[44:45]
    v_pk_mul_f32 v[14:15], v[14:15], s[44:45]
    v_cvt_pk_bf16_f32 v8, v8, v9
    v_cvt_pk_bf16_f32 v9, v10, v11
    v_cvt_pk_bf16_f32 v10, v12, v13
    v_cvt_pk_bf16_f32 v11, v14, v15
    buffer_store_dwordx4 v[8:11], v47, s[32:35], 0 offen

    s_endpgm
k1_frag:
    s_and_b32 s47, s3, 7
    s_lshl_b32 s48, s47, 5
    v_xor_b32 v44, s48, v45
    s_lshr_b32 s49, s3, 3
    s_lshl_b32 s50, s49, 14
    v_add_u32 v44, s50, v44
    ds_read_b64_tr_b16 v[32:33], v44
    ds_read_b64_tr_b16 v[34:35], v44 offset:1024
    ds_read_b64_tr_b16 v[36:37], v44 offset:8192
    ds_read_b64_tr_b16 v[38:39], v44 offset:9216

    s_add_u32 s32, s20, 2621440
    s_addc_u32 s33, s21, 0
    s_and_b32 s33, s33, 0xffff
    s_mov_b32 s34, 98304
    s_mov_b32 s35, 0x20000
    s_lshl_b32 s50, s23, 3
    s_add_u32 s47, s47, s50
    s_lshl_b32 s47, s47, 12
    s_lshl_b32 s49, s49, 11
    s_add_u32 s47, s47, s49
    v_lshlrev_b32 v5, 4, v2
    s_waitcnt lgkmcnt(0)
    buffer_store_dwordx4 v[32:35], v5, s[32:35], s47 offen
    buffer_store_dwordx4 v[36:39], v5, s[32:35], s47 offen offset:1024

k1_end:
    s_endpgm
.globl mpnn_edge_kernel
.p2align 8
.type mpnn_edge_kernel,@function
mpnn_edge_kernel:
    s_load_dwordx16 s[4:19], s[0:1], 0
    s_load_dwordx2 s[20:21], s[0:1], 64
    s_cmp_ge_u32 s2, 256
    s_cbranch_scc1 k2_end
    v_lshrrev_b32 v2, 6, v0
    v_and_b32 v1, 63, v0
    v_readfirstlane_b32 s3, v2
    s_mul_i32 s22, s2, 625
    s_add_u32 s23, s22, 640
    s_add_u32 s22, s22, 15
    s_lshr_b32 s22, s22, 4
    s_lshr_b32 s23, s23, 4
    s_sub_u32 s23, s23, s22

    v_lshlrev_b32 v2, 2, v1
    v_mov_b32 v8, 0
    ds_write_b32 v2, v8 offset:54288
    v_add_u32 v4, -512, v0
    v_lshlrev_b32 v6, 2, v4
    v_lshlrev_b32 v3, 4, v0
    s_mul_i32 s44, s2, 12800
    s_add_u32 s44, s44, 2752512
    s_mul_i32 s45, s2, 3200
    s_add_u32 s45, s45, 6029312
    s_mov_b32 s68, 1.0
    s_mov_b32 s69, 1.0
    s_waitcnt lgkmcnt(0)
    s_barrier
    s_cmp_lt_u32 s3, 8
    s_cbranch_scc1 k2_consts

    s_setprio 2
    s_add_u32 s28, s20, s45
    s_addc_u32 s29, s21, 0
    s_and_b32 s29, s29, 0xffff
    s_mov_b32 s30, 3200
    s_mov_b32 s31, 0x20000

    buffer_load_ubyte v32, v4, s[28:31], 0 offen offset:0
    buffer_load_ubyte v33, v4, s[28:31], 0 offen offset:512
    buffer_load_ubyte v34, v4, s[28:31], 0 offen offset:1024
    buffer_load_ubyte v35, v4, s[28:31], 0 offen offset:1536
    buffer_load_ubyte v36, v4, s[28:31], 0 offen offset:2048
    buffer_load_ubyte v37, v4, s[28:31], 0 offen offset:2560
    buffer_load_ubyte v38, v4, s[28:31], 0 offen offset:3072
    s_add_u32 s24, s20, s44
    s_addc_u32 s25, s21, 0
    s_and_b32 s25, s25, 0xffff
    s_mov_b32 s26, 12800
    s_mov_b32 s27, 0x20000

    buffer_load_dword v40, v6, s[24:27], 0 offen offset:0
    buffer_load_dword v41, v6, s[24:27], 0 offen offset:2048
    s_mov_b32 s44, 4096
    buffer_load_dword v42, v6, s[24:27], s44 offen
    s_mov_b32 s44, 6144
    buffer_load_dword v43, v6, s[24:27], s44 offen
    s_mov_b32 s44, 8192
    buffer_load_dword v44, v6, s[24:27], s44 offen
    s_mov_b32 s44, 10240
    buffer_load_dword v45, v6, s[24:27], s44 offen
    s_mov_b32 s44, 12288
    buffer_load_dword v46, v6, s[24:27], s44 offen
    s_add_u32 s40, s20, 6881280
    s_addc_u32 s41, s21, 0
    s_and_b32 s41, s41, 0xffff
    s_mov_b32 s42, 400
    s_mov_b32 s43, 0x20000
    s_cmp_eq_u32 s3, 15
    s_cselect_b32 s42, 400, 0
    v_lshlrev_b32 v122, 3, v1
    buffer_load_dwordx2 v[120:121], v122, s[40:43], 0 offen

    v_lshlrev_b32 v108, 2, v6
    v_mov_b32 v110, 0x3f80
    v_mov_b32 v111, 1.0

    ds_write_b64 v108, v[110:111] offset:8
    ds_write_b64 v108, v[110:111] offset:8200
    ds_write_b64 v108, v[110:111] offset:16392
    ds_write_b64 v108, v[110:111] offset:24584
    ds_write_b64 v108, v[110:111] offset:32776
    ds_write_b64 v108, v[110:111] offset:40968
    v_cmp_gt_u32 vcc, 320, v4
    s_mov_b64 exec, vcc
    ds_write_b64 v108, v[110:111] offset:49160
    s_mov_b64 exec, -1
    v_mov_b32 v64, 0
    v_mov_b32 v65, 0
    v_mov_b32 v66, 0
    v_mov_b32 v67, 0
    v_lshrrev_b32 v96, 5, v4
    v_mov_b32 v97, 800
    v_mul_u32_u24 v96, v96, v97
    v_and_b32 v97, 31, v4
    v_lshl_add_u32 v96, v97, 4, v96
    v_add_u32 v96, 71424, v96
    ds_write_b128 v96, v[64:67]
    ds_write_b128 v96, v[64:67] offset:12800
    ds_write_b128 v96, v[64:67] offset:25600
    s_cmp_eq_u32 s3, 14
    s_cbranch_scc0 k2_s_nozr
    v_lshlrev_b32 v96, 3, v1
    v_add_u32 v96, 126208, v96
    ds_write_b64 v96, v[64:65]

k2_s_nozr:
k2_consts:
    v_lshrrev_b32 v102, 5, v1
    v_and_b32 v108, 3, v1
    v_lshlrev_b32 v5, 6, v102
    v_lshl_add_u32 v5, v108, 4, v5
    v_mov_b32 v7, v5
    v_bfe_u32 v106, v1, 2, 1
    v_lshlrev_b32 v106, 6, v106
    v_bfe_u32 v110, v1, 4, 1
    v_lshl_add_u32 v106, v110, 5, v106
    v_bfe_u32 v111, v1, 3, 1
    v_lshl_add_u32 v106, v111, 4, v106
    v_lshl_add_u32 v106, v108, 2, v106
    v_add_u32 v106, 71424, v106

    v_mov_b32 v108, 0x3f800000
    v_mov_b32 v109, 0x3f80
    s_mov_b32 s44, 0xaaaaaaaa
    s_mov_b32 s45, 0xaaaaaaaa
    v_cndmask_b32 v111, v109, v108, s[44:45]

    s_mov_b32 s44, 0x3
    s_mov_b32 s45, 0x300
    v_cndmask_b32 v20, 0, v111, s[44:45]
    s_mov_b32 s44, 0x30000
    s_mov_b32 s45, 0x3000000
    v_cndmask_b32 v16, 0, v111, s[44:45]
    s_mov_b32 s44, 0xc
    s_mov_b32 s45, 0xc00
    v_cndmask_b32 v21, 0, v111, s[44:45]
    s_mov_b32 s44, 0xc0000
    s_mov_b32 s45, 0xc000000
    v_cndmask_b32 v17, 0, v111, s[44:45]
    s_mov_b32 s44, 0x30
    s_mov_b32 s45, 0x3000
    v_cndmask_b32 v22, 0, v111, s[44:45]
    s_mov_b32 s44, 0x300000
    s_mov_b32 s45, 0x30000000
    v_cndmask_b32 v18, 0, v111, s[44:45]
    s_mov_b32 s44, 0xc0
    s_mov_b32 s45, 0xc000
    v_cndmask_b32 v23, 0, v111, s[44:45]
    s_mov_b32 s44, 0xc00000
    s_mov_b32 s45, 0xc0000000
    v_cndmask_b32 v19, 0, v111, s[44:45]
    v_sub_u32 v103, 1, v102
    v_and_b32 v109, 1, v1
    v_lshlrev_b32 v109, 5, v109
    v_bfe_u32 v110, v1, 4, 1
    v_lshl_add_u32 v109, v110, 4, v109
    v_bfe_u32 v111, v1, 1, 1
    v_lshl_add_u32 v109, v111, 3, v109
    v_bfe_u32 v111, v1, 2, 2
    v_and_b32 v104, 1, v111
    v_lshlrev_b32 v104, 8, v104
    v_lshrrev_b32 v105, 1, v111
    v_lshl_add_u32 v104, v105, 6, v104
    v_add_u32 v104, 55040, v104
    v_lshlrev_b32 v105, 6, v111
    v_add_u32 v105, 71952, v105
    s_mov_b32 s44, 0
    s_mov_b32 s45, -1
    v_cndmask_b32 v104, v104, v105, s[44:45]
    v_add_u32 v104, v104, v109
    v_lshl_add_u32 v105, v103, 7, v104
    s_mov_b32 s68, 1.0
    s_mov_b32 s69, 1.0

    s_cmp_lt_u32 s3, 8
    s_cbranch_scc0 k2_S_B

    s_mov_b32 s52, 0
    s_mov_b32 s28, s4
    s_and_b32 s29, s5, 0xffff
    s_mov_b32 s30, 2560000
    s_mov_b32 s31, 0x20000
    s_lshl_b32 s44, s22, 8
    s_add_u32 s45, s44, 8192
    buffer_load_dwordx4 v[24:27], v3, s[28:31], s44 offen
    s_cmp_lt_u32 s3, 4
    s_cselect_b32 s30, 2560000, 0
    buffer_load_dwordx4 v[28:31], v3, s[28:31], s45 offen

    s_add_u32 s32, s20, 2621440
    s_addc_u32 s33, s21, 0
    s_and_b32 s33, s33, 0xffff
    s_mov_b32 s34, 98304
    s_mov_b32 s35, 0x20000
    v_lshlrev_b32 v4, 4, v1
    s_lshl_b32 s58, s3, 12

    buffer_load_dwordx4 v[32:35], v4, s[32:35], s58 offen offset:0
    buffer_load_dwordx4 v[36:39], v4, s[32:35], s58 offen offset:1024
    buffer_load_dwordx4 v[40:43], v4, s[32:35], s58 offen offset:2048
    buffer_load_dwordx4 v[44:47], v4, s[32:35], s58 offen offset:3072
    s_mov_b32 s40, s12
    s_and_b32 s41, s13, 0xffff
    s_mov_b32 s42, 65792
    s_mov_b32 s43, 0x20000
    s_cmp_eq_u32 s3, 7
    s_cselect_b32 s42, 65792, 0
    s_mov_b32 s44, 65536
    buffer_load_dword v99, v2, s[40:43], s44 offen

    s_branch k2_A_G
k2_S_B:
    v_mov_b32 v28, 1

    v_mov_b32 v84, 10000
    v_mov_b32 v85, 0
    v_mov_b32 v86, 0
    v_mov_b32 v87, 0
    v_mov_b32 v31, 800
    v_mul_u32_u24 v31, v1, v31
    v_mov_b32 v29, 54540
    s_sub_u32 s46, s3, 8

    s_waitcnt vmcnt(8)
    v_cmp_ne_u32 s[70:71], 0, v32
    v_lshlrev_b32 v48, 2, v32
    v_cmp_ne_u32 s[72:73], 0, v33
    v_lshlrev_b32 v49, 2, v33
    v_cmp_ne_u32 s[74:75], 0, v34
    v_lshlrev_b32 v50, 2, v34
    v_cmp_ne_u32 s[76:77], 0, v35
    v_lshlrev_b32 v51, 2, v35
    v_cmp_ne_u32 s[78:79], 0, v36
    v_lshlrev_b32 v52, 2, v36
    v_cmp_ne_u32 s[80:81], 0, v37
    v_lshlrev_b32 v53, 2, v37
    v_cmp_ne_u32 s[82:83], 0, v38
    v_lshlrev_b32 v54, 2, v38
    s_mov_b64 exec, s[70:71]
    ds_add_rtn_u32 v56, v48, v28 offset:54284
    s_mov_b64 exec, s[72:73]
    ds_add_rtn_u32 v57, v49, v28 offset:54284
    s_mov_b64 exec, s[74:75]
    ds_add_rtn_u32 v58, v50, v28 offset:54284
    s_mov_b64 exec, s[76:77]
    ds_add_rtn_u32 v59, v51, v28 offset:54284
    s_mov_b64 exec, s[78:79]
    ds_add_rtn_u32 v60, v52, v28 offset:54284
    s_mov_b64 exec, s[80:81]
    ds_add_rtn_u32 v61, v53, v28 offset:54284
    s_mov_b64 exec, s[82:83]
    ds_add_rtn_u32 v62, v54, v28 offset:54284
    s_mov_b64 exec, -1
    s_waitcnt vmcnt(0)
    v_or_b32 v120, v120, v121
    v_cmp_ne_u32 vcc, 0, v120
    s_cbranch_vccnz k2_setflag

k2_noflag:
    s_mov_b32 s44, 0x03020302
    v_and_b32 v64, 0xffff, v40
    v_perm_b32 v65, v40, v40, s44
    v_and_b32 v66, 0xffff, v41
    v_perm_b32 v67, v41, v41, s44
    v_and_b32 v68, 0xffff, v42
    v_perm_b32 v69, v42, v42, s44
    v_and_b32 v70, 0xffff, v43
    v_perm_b32 v71, v43, v43, s44
    v_and_b32 v72, 0xffff, v44
    v_perm_b32 v73, v44, v44, s44
    v_and_b32 v74, 0xffff, v45
    v_perm_b32 v75, v45, v45, s44
    v_and_b32 v76, 0xffff, v46
    v_perm_b32 v77, v46, v46, s44
    s_waitcnt lgkmcnt(0)
    s_mov_b64 exec, 1
    ds_add_u32 v29, v28
    s_mov_b64 exec, -1

k2_spin:
    ds_read_b32 v24, v2 offset:54288
    s_waitcnt lgkmcnt(0)
    v_readlane_b32 s44, v24, 63
    s_cmp_lt_u32 s44, 8
    s_cbranch_scc1 k2_spin

    s_mov_b32 s36, s20
    s_and_b32 s37, s21, 0xffff
    s_mov_b32 s38, 2560256
    s_mov_b32 s39, 0x20000
    s_lshr_b32 s44, s2, 3
    s_and_b32 s44, s44, 31
    s_mul_i32 s44, s44, 81920
    s_cmp_lt_u32 s46, 3
    s_cselect_b32 s38, 2560256, 0
    s_lshl_b32 s45, s46, 13
    s_add_u32 s44, s44, s45
    v_lshlrev_b32 v98, 7, v1
    buffer_load_dword v99, v98, s[36:39], s44 offen

    v_add_u32 v25, 3, v24
    v_and_b32 v25, -4, v25
    s_mov_b32 s44, -1
    s_mov_b32 s45, 0xffff
    v_cndmask_b32 v25, 0, v25, s[44:45]
    v_cndmask_b32 v24, 0, v24, s[44:45]
    v_mov_b32 v26, v25
    s_nop 1

    v_add_u32_dpp v26, v26, v26 row_shr:1 row_mask:0xf bank_mask:0xf bound_ctrl:0
    s_nop 1
    v_add_u32_dpp v26, v26, v26 row_shr:2 row_mask:0xf bank_mask:0xf bound_ctrl:0
    s_nop 1
    v_add_u32_dpp v26, v26, v26 row_shr:4 row_mask:0xf bank_mask:0xf bound_ctrl:0
    s_nop 1
    v_add_u32_dpp v26, v26, v26 row_shr:8 row_mask:0xf bank_mask:0xf bound_ctrl:0
    s_nop 1
    v_add_u32_dpp v26, v26, v26 row_bcast:15 row_mask:0xa bank_mask:0xf
    s_nop 1
    v_add_u32_dpp v26, v26, v26 row_bcast:31 row_mask:0xc bank_mask:0xf
    v_sub_u32 v27, v26, v25
    v_lshlrev_b32 v28, 4, v27
    ds_write_b32 v2, v28 offset:54544
    v_readlane_b32 s60, v26, 63
    v_add_u32 v28, s46, v24
    v_cmp_lt_u32 vcc, v28, v25
    v_add_lshl_u32 v28, v28, v27, 4
    s_lshl_b32 s44, s46, 2
    v_add_u32 v29, s44, v27
    v_add_u32 v30, v27, v25
    s_mov_b32 s58, s60
    s_mov_b64 s[54:55], vcc
    s_mov_b32 s53, s46

    s_lshr_b32 s60, s60, 2
    s_add_u32 s60, s60, 1
    s_lshr_b32 s60, s60, 1
    s_cmp_gt_u32 s60, 8
    s_cselect_b32 s46, 4, 0
    s_sub_u32 s47, s60, s46
    s_mul_i32 s44, s3, s47
    s_add_u32 s45, s44, s47
    s_lshl_b32 s46, s46, 1
    s_sub_i32 s48, s3, 8
    s_max_i32 s48, s48, 0
    s_mul_i32 s48, s48, s46
    s_add_u32 s44, s44, s48
    s_sub_i32 s48, s3, 7
    s_max_i32 s48, s48, 0
    s_mul_i32 s48, s48, s46
    s_add_u32 s45, s45, s48
    s_lshr_b32 s44, s44, 4
    s_lshr_b32 s45, s45, 4
    s_sub_u32 s61, s45, s44
    s_lshl_b32 s59, s44, 1
    v_and_b32 v109, 31, v1
    v_mul_u32_u24 v101, s61, v102
    v_add3_u32 v101, v101, v109, s59
    v_lshlrev_b32 v101, 2, v101
    v_add_u32 v108, -4, v101
    v_max_i32 v108, 0, v108
    v_bfe_u32 v109, v1, 2, 1
    v_mul_u32_u24 v100, s61, v109
    v_add_u32 v100, s59, v100
    v_bfe_u32 v109, v1, 3, 2
    v_lshl_add_u32 v100, v100, 2, v109
    v_lshlrev_b32 v100, 4, v100
    v_and_b32 v109, 1, v1
    v_lshl_add_u32 v109, v109, 2, 4
    v_mad_u32_u24 v110, v109, v102, v100
    v_add_u32 v110, 4, v110
    s_lshl_b32 s45, s3, 10
    s_add_u32 s45, s45, 38400
    v_lshl_add_u32 v107, v102, 9, v106
    v_add_u32 v107, s45, v107

    s_waitcnt lgkmcnt(0)
    ds_read_b32 v32, v48 offset:54540
    ds_read_b32 v33, v49 offset:54540
    ds_read_b32 v34, v50 offset:54540
    ds_read_b32 v35, v51 offset:54540
    ds_read_b32 v36, v52 offset:54540
    ds_read_b32 v37, v53 offset:54540
    ds_read_b32 v38, v54 offset:54540
    s_cmp_lt_u32 s53, 3
    s_cbranch_scc0 k2_nopad
    s_mov_b64 exec, s[54:55]
    ds_write_b128 v28, v[84:87]
    s_mov_b64 exec, -1

k2_nopad:
k2_subn_loop:
    v_cmp_lt_u32 vcc, v29, v30
    s_and_b64 exec, exec, vcc
    s_cbranch_execz k2_subn_done
    ds_write_b32 v29, v31 offset:55552
    v_add_u32 v29, 32, v29
    s_branch k2_subn_loop

k2_subn_done:
    s_mov_b64 exec, -1
    s_cmp_eq_u32 s53, 3
    s_cbranch_scc0 k2_nodummy
    s_mov_b64 exec, 15
    v_add_u32 v24, s58, v1
    v_lshlrev_b32 v24, 4, v24
    v_mov_b32 v25, s58
    v_mov_b32 v26, 37600
    v_mov_b32 v27, 54928
    ds_write_b128 v24, v[84:87]
    ds_write_b32 v25, v26 offset:55552
    ds_write_b32 v27, v25

k2_nodummy:
    s_waitcnt lgkmcnt(0)
    s_mov_b64 exec, s[70:71]
    v_lshl_add_u32 v32, v56, 4, v32
    ds_write_b64 v32, v[64:65]

    s_mov_b64 exec, s[72:73]
    v_lshl_add_u32 v33, v57, 4, v33
    ds_write_b64 v33, v[66:67]

    s_mov_b64 exec, s[74:75]
    v_lshl_add_u32 v34, v58, 4, v34
    ds_write_b64 v34, v[68:69]

    s_mov_b64 exec, s[76:77]
    v_lshl_add_u32 v35, v59, 4, v35
    ds_write_b64 v35, v[70:71]

    s_mov_b64 exec, s[78:79]
    v_lshl_add_u32 v36, v60, 4, v36
    ds_write_b64 v36, v[72:73]

    s_mov_b64 exec, s[80:81]
    v_lshl_add_u32 v37, v61, 4, v37
    ds_write_b64 v37, v[74:75]

    s_cmp_eq_u64 s[82:83], 0
    s_cbranch_scc1 k2_nos6

    s_mov_b64 exec, s[82:83]
    v_lshl_add_u32 v38, v62, 4, v38
    ds_write_b64 v38, v[76:77]

k2_nos6:
    s_mov_b64 exec, -1
    s_setprio 0
    s_waitcnt lgkmcnt(0)
    s_barrier

k2_main:
    ds_read_b32 v4, v100
    ds_read_b32 v109, v101 offset:55552
    ds_read_b32 v108, v108 offset:55552
    ds_read_b32 v6, v100 offset:64
    v_mov_b32 v28, 0
    v_mov_b32 v29, 0
    v_mov_b32 v30, 0
    v_mov_b32 v31, 0

    s_mov_b32 s70, 0x11111111
    s_mov_b32 s71, 0x3030303
    s_mov_b32 s72, 0x22222222
    s_mov_b32 s73, 0xc0c0c0c
    s_mov_b32 s74, 0x44444444
    s_mov_b32 s75, 0x30303030
    s_mov_b32 s76, 0x88888888
    s_mov_b32 s77, 0xc0c0c0c0
    s_mov_b64 exec, s[70:71]
    ds_read_b32 v28, v110 offset:0
    s_mov_b64 exec, s[72:73]
    ds_read_b32 v29, v110 offset:0
    s_mov_b64 exec, s[74:75]
    ds_read_b32 v30, v110 offset:0
    s_mov_b64 exec, s[76:77]
    ds_read_b32 v31, v110 offset:0
    s_mov_b64 exec, -1
    s_mov_b32 s36, s20
    s_and_b32 s37, s21, 0xffff
    s_or_b32 s37, s37, 16777216
    s_mov_b32 s38, 10001
    s_mov_b32 s39, 0x20000
    s_mov_b32 s49, 0
    s_cmp_gt_u32 s61, 0
    s_cselect_b32 s38, 10001, 0
    s_waitcnt lgkmcnt(7)
    buffer_load_dwordx4 v[48:51], v[4:5], s[36:39], 0 idxen offen
    buffer_load_dwordx4 v[52:55], v[4:5], s[36:39], 0 idxen offen offset:128

    s_waitcnt lgkmcnt(4)
    v_mov_b32 v101, v109
    v_cmp_ne_u32 vcc, v108, v109
    ds_read_b32 v4, v100 offset:128
    s_lshl_b32 s45, s3, 3
    v_lshl_add_u32 v111, v102, 2, s45
    v_mov_b32 v108, v101
    s_mov_b32 s62, vcc_lo
    s_mov_b32 s63, vcc_hi
    s_cmp_eq_u32 s61, 0
    s_cbranch_scc0 k2_hn
    v_mov_b32 v108, -1

k2_hn:
    s_mov_b32 exec_lo, 1
    s_mov_b32 exec_hi, 1
    ds_write_b32 v111, v108 offset:54800
    s_mov_b32 exec_hi, 0
    v_mov_b32 v108, 54532
    v_mov_b32 v109, 1
    ds_add_u32 v108, v109
    s_mov_b64 exec, -1
    s_lshl_b32 s44, 1, s61
    s_or_b32 s62, s62, s44
    s_or_b32 s63, s63, s44
    s_or_b32 s64, s62, s63
    s_mov_b32 s44, 32
    v_readlane_b32 s65, v101, 0
    v_readlane_b32 s66, v101, s44
    v_mov_b32 v111, 54536

k2_qspin:
    ds_read_b32 v108, v111
    s_waitcnt lgkmcnt(0)
    v_readfirstlane_b32 s44, v108
    s_cmp_lt_u32 s44, 8
    s_cbranch_scc1 k2_qspin
    s_cmp_gt_u32 s61, 1
    s_cselect_b32 s38, 10001, 0
    v_mad_u32_u24 v108, v102, s65, v104
    v_mad_u32_u24 v109, v102, s66, v105
    ds_read_b64_tr_b16 v[24:25], v108
    ds_read_b64_tr_b16 v[26:27], v109
    buffer_load_dwordx4 v[56:59], v[6:7], s[36:39], 0 idxen offen
    buffer_load_dwordx4 v[60:63], v[6:7], s[36:39], 0 idxen offen offset:128
    ds_read_b32 v6, v100 offset:192
    v_mov_b32 v8, 0
    v_mov_b32 v9, 0
    v_mov_b32 v10, 0
    v_mov_b32 v11, 0
    v_mov_b32 v2, 0
    v_mov_b32 v3, 0
    s_cmp_eq_u32 s61, 0
    s_cbranch_scc1 k2_main_done
    s_waitcnt lgkmcnt(0)
    s_waitcnt vmcnt(2)

    v_mfma_f32_32x32x16_bf16 v[64:79], v[48:51], v[20:23], 0
    v_mfma_f32_32x32x16_bf16 v[64:79], v[52:55], v[16:19], v[64:79]
    v_mfma_f32_32x32x16_bf16 v[64:79], v[28:31], v[24:27], v[64:79]

    s_mov_b64 exec, s[70:71]
    ds_read_b32 v28, v110 offset:64
    s_mov_b64 exec, s[72:73]
    ds_read_b32 v29, v110 offset:64
    s_mov_b64 exec, s[74:75]
    ds_read_b32 v30, v110 offset:64
    s_mov_b64 exec, s[76:77]
    ds_read_b32 v31, v110 offset:64
    s_mov_b64 exec, -1
    s_mov_b32 s60, 0
    s_lshr_b32 s54, s61, 2
    s_max_u32 s54, s54, 1
    s_lshr_b32 s44, s61, 1
    s_max_u32 s44, s44, 1
    s_cmp_lt_u32 s3, 8
    s_cselect_b32 s54, s54, s44
    s_mov_b32 s55, 0

    s_add_u32 s32, s20, 2621440
    s_addc_u32 s33, s21, 0
    s_and_b32 s33, s33, 0xffff
    s_mov_b32 s34, 98304
    s_mov_b32 s35, 0x20000
    s_lshl_b32 s44, s3, 12
    s_add_u32 s53, s44, 65536
    s_add_u32 s44, s44, 126720
    s_mov_b32 m0, s44

    s_lshr_b32 s44, s61, 1
    s_lshl_b32 s57, 1, s44
    s_sub_u32 s45, s61, 2
    s_max_i32 s45, s45, 0
    s_lshl_b32 s46, 1, s45
    s_or_b32 s57, s57, s46
    s_sub_u32 s45, s61, 1
    s_max_i32 s45, s45, 0
    s_lshl_b32 s46, 1, s45
    s_or_b32 s57, s57, s46
    s_mov_b32 s56, 3
    s_setprio 3

    s_mov_b32 s67, 1
    s_bitcmp1_b32 s64, s67
    s_cbranch_scc0 k2_nob2_f
    s_mov_b32 s44, 33
    v_readlane_b32 s65, v101, s67
    v_readlane_b32 s66, v101, s44
    s_nop 1
    v_mad_u32_u24 v108, v102, s65, v104
    v_mad_u32_u24 v109, v102, s66, v105
    ds_read_b64_tr_b16 v[24:25], v108
    ds_read_b64_tr_b16 v[26:27], v109

k2_nob2_f:
    s_nop 4
    v_exp_f32 v32, v64
    v_exp_f32 v33, v65
    v_exp_f32 v34, v66
    v_exp_f32 v35, v67
    v_exp_f32 v36, v68
    v_exp_f32 v37, v69
    v_exp_f32 v38, v70
    v_exp_f32 v39, v71
    v_exp_f32 v40, v72
    v_exp_f32 v41, v73
    v_exp_f32 v42, v74
    v_exp_f32 v43, v75
    v_exp_f32 v44, v76
    v_exp_f32 v45, v77
    v_exp_f32 v46, v78
    v_exp_f32 v47, v79
    v_pk_add_f32 v[36:37], v[36:37], s[68:69]
    v_pk_add_f32 v[38:39], v[38:39], s[68:69]
    v_pk_add_f32 v[44:45], v[44:45], s[68:69]
    v_pk_add_f32 v[46:47], v[46:47], s[68:69]
    v_pk_fma_f32 v[112:113], v[68:69], v[32:33], v[68:69]
    v_pk_fma_f32 v[114:115], v[70:71], v[34:35], v[70:71]
    v_pk_fma_f32 v[32:33], v[32:33], v[36:37], v[36:37]
    v_pk_fma_f32 v[34:35], v[34:35], v[38:39], v[38:39]
    v_pk_fma_f32 v[112:113], v[64:65], v[36:37], v[112:113]
    v_pk_fma_f32 v[114:115], v[66:67], v[38:39], v[114:115]
    v_pk_fma_f32 v[36:37], v[76:77], v[40:41], v[76:77]
    v_pk_fma_f32 v[38:39], v[78:79], v[42:43], v[78:79]
    v_pk_fma_f32 v[40:41], v[40:41], v[44:45], v[44:45]
    v_pk_fma_f32 v[42:43], v[42:43], v[46:47], v[46:47]
    v_pk_fma_f32 v[36:37], v[72:73], v[44:45], v[36:37]
    v_pk_fma_f32 v[38:39], v[74:75], v[46:47], v[38:39]
    v_pk_mul_f32 v[12:13], v[32:33], v[40:41]
    v_pk_mul_f32 v[14:15], v[34:35], v[42:43]
    v_pk_mul_f32 v[112:113], v[112:113], v[40:41]
    v_pk_mul_f32 v[114:115], v[114:115], v[42:43]
    v_pk_fma_f32 v[96:97], v[36:37], v[32:33], v[112:113]
    v_pk_fma_f32 v[98:99], v[38:39], v[34:35], v[114:115]
    s_bitcmp1_b32 s64, s67
    s_cbranch_scc0 k2_nofl_f

    v_rcp_f32 v40, v12
    v_rcp_f32 v42, v14
    v_rcp_f32 v41, v13
    v_rcp_f32 v43, v15
    v_pk_fma_f32 v[2:3], v[12:13], v[14:15], v[2:3]
    v_pk_fma_f32 v[8:9], v[96:97], v[40:41], v[8:9]
    v_pk_fma_f32 v[10:11], v[98:99], v[42:43], v[10:11]
    s_bitcmp1_b32 s62, s67
    s_cselect_b32 exec_lo, -1, 0
    s_bitcmp1_b32 s63, s67
    s_cselect_b32 exec_hi, -1, 0
    ds_write_b32 v107, v8
    ds_write_b32 v107, v9 offset:128
    ds_write_b32 v107, v10 offset:256
    ds_write_b32 v107, v11 offset:384
    v_pk_fma_f32 v[2:3], v[8:9], v[8:9], v[2:3]
    v_pk_fma_f32 v[2:3], v[10:11], v[10:11], v[2:3]
    v_mad_u32_u24 v107, v102, s66, v106
    v_mad_u32_u24 v107, v103, s65, v107
    v_pk_mov_b32 v[8:9], 0, 0
    v_pk_mov_b32 v[10:11], 0, 0
    s_mov_b64 exec, -1

k2_nofl_f:
    s_cmp_gt_u32 s61, 2
    s_cselect_b32 s38, 10001, 0
    buffer_load_dwordx4 v[48:51], v[4:5], s[36:39], 0 idxen offen
    buffer_load_dwordx4 v[52:55], v[4:5], s[36:39], 0 idxen offen offset:128
    s_mov_b32 s60, 1
    s_cmp_ge_u32 s60, s61
    s_cbranch_scc1 k2_main_done
    s_waitcnt vmcnt(2) lgkmcnt(0)
    ds_read_b32 v4, v100 offset:256
    v_mfma_f32_32x32x16_bf16 v[80:95], v[56:59], v[20:23], 0
    v_mfma_f32_32x32x16_bf16 v[80:95], v[60:63], v[16:19], v[80:95]
    v_mfma_f32_32x32x16_bf16 v[80:95], v[28:31], v[24:27], v[80:95]

    s_mov_b64 exec, s[70:71]
    ds_read_b32 v28, v110 offset:128
    s_mov_b64 exec, s[72:73]
    ds_read_b32 v29, v110 offset:128
    s_mov_b64 exec, s[74:75]
    ds_read_b32 v30, v110 offset:128
    s_mov_b64 exec, s[76:77]
    ds_read_b32 v31, v110 offset:128
    s_mov_b64 exec, -1
    s_cmp_gt_u32 s61, 3
    s_cselect_b32 s38, 10001, 0
    buffer_load_dwordx4 v[56:59], v[6:7], s[36:39], 0 idxen offen
    buffer_load_dwordx4 v[60:63], v[6:7], s[36:39], 0 idxen offen offset:128
    s_branch k2_loop1

k2_loop:
    s_add_u32 s67, s60, 1
    s_bitcmp1_b32 s64, s67
    s_cbranch_scc0 k2_nob2_0
    s_add_u32 s44, s67, 32
    v_readlane_b32 s65, v101, s67
    v_readlane_b32 s66, v101, s44
    s_nop 1
    v_mad_u32_u24 v108, v102, s65, v104
    v_mad_u32_u24 v109, v102, s66, v105
    ds_read_b64_tr_b16 v[24:25], v108
    ds_read_b64_tr_b16 v[26:27], v109

k2_nob2_0:
    s_cmp_lg_u32 s55, 0
    s_cbranch_scc1 k2_w6_0
    s_waitcnt vmcnt(2) lgkmcnt(0)

k2_wd_0:
    v_mfma_f32_32x32x16_bf16 v[80:95], v[56:59], v[20:23], 0

    v_exp_f32 v32, v64
    v_exp_f32 v33, v65
    v_exp_f32 v34, v66
    v_exp_f32 v35, v67
    v_exp_f32 v36, v68
    v_mfma_f32_32x32x16_bf16 v[80:95], v[60:63], v[16:19], v[80:95]
    v_exp_f32 v37, v69
    v_exp_f32 v38, v70
    v_exp_f32 v39, v71
    v_exp_f32 v40, v72
    v_exp_f32 v41, v73
    v_mfma_f32_32x32x16_bf16 v[80:95], v[28:31], v[24:27], v[80:95]
    s_add_u32 s44, s60, 3
    s_cmp_lt_u32 s44, s61
    s_cselect_b32 s38, 10001, 0
    buffer_load_dwordx4 v[56:59], v[6:7], s[36:39], 0 idxen offen
    buffer_load_dwordx4 v[60:63], v[6:7], s[36:39], 0 idxen offen offset:128
    ds_read_b32 v4, v100 offset:256

    s_mov_b64 exec, s[70:71]
    ds_read_b32 v28, v110 offset:128
    s_mov_b64 exec, s[72:73]
    ds_read_b32 v29, v110 offset:128
    s_mov_b64 exec, s[74:75]
    ds_read_b32 v30, v110 offset:128
    s_mov_b64 exec, s[76:77]
    ds_read_b32 v31, v110 offset:128
    s_mov_b64 exec, -1
    s_cmp_eq_u32 s60, s54
    s_cbranch_scc1 k2_dma_0

k2_dmad_0:
    v_exp_f32 v42, v74
    v_exp_f32 v43, v75
    v_exp_f32 v44, v76
    v_exp_f32 v45, v77
    v_exp_f32 v46, v78
    v_exp_f32 v47, v79
    v_pk_add_f32 v[36:37], v[36:37], s[68:69]
    v_pk_add_f32 v[38:39], v[38:39], s[68:69]
    v_pk_add_f32 v[44:45], v[44:45], s[68:69]
    v_pk_add_f32 v[46:47], v[46:47], s[68:69]
    v_pk_fma_f32 v[112:113], v[68:69], v[32:33], v[68:69]
    v_pk_fma_f32 v[114:115], v[70:71], v[34:35], v[70:71]
    v_pk_fma_f32 v[32:33], v[32:33], v[36:37], v[36:37]
    v_pk_fma_f32 v[34:35], v[34:35], v[38:39], v[38:39]
    v_pk_fma_f32 v[112:113], v[64:65], v[36:37], v[112:113]
    v_pk_fma_f32 v[114:115], v[66:67], v[38:39], v[114:115]
    v_pk_fma_f32 v[36:37], v[76:77], v[40:41], v[76:77]
    v_pk_fma_f32 v[38:39], v[78:79], v[42:43], v[78:79]
    v_pk_fma_f32 v[40:41], v[40:41], v[44:45], v[44:45]
    v_pk_fma_f32 v[42:43], v[42:43], v[46:47], v[46:47]
    v_pk_fma_f32 v[36:37], v[72:73], v[44:45], v[36:37]
    v_pk_fma_f32 v[38:39], v[74:75], v[46:47], v[38:39]
    v_pk_mul_f32 v[12:13], v[32:33], v[40:41]
    v_pk_mul_f32 v[14:15], v[34:35], v[42:43]
    v_pk_mul_f32 v[112:113], v[112:113], v[40:41]
    v_pk_mul_f32 v[114:115], v[114:115], v[42:43]
    v_pk_fma_f32 v[96:97], v[36:37], v[32:33], v[112:113]
    v_pk_fma_f32 v[98:99], v[38:39], v[34:35], v[114:115]
    s_bitcmp1_b32 s64, s67
    s_cbranch_scc0 k2_nofl_0

    v_rcp_f32 v40, v12
    v_rcp_f32 v42, v14
    v_rcp_f32 v41, v13
    v_rcp_f32 v43, v15
    v_pk_fma_f32 v[2:3], v[12:13], v[14:15], v[2:3]
    v_pk_fma_f32 v[8:9], v[96:97], v[40:41], v[8:9]
    v_pk_fma_f32 v[10:11], v[98:99], v[42:43], v[10:11]
    s_bitcmp1_b32 s62, s67
    s_cselect_b32 exec_lo, -1, 0
    s_bitcmp1_b32 s63, s67
    s_cselect_b32 exec_hi, -1, 0
    ds_write_b32 v107, v8
    ds_write_b32 v107, v9 offset:128
    ds_write_b32 v107, v10 offset:256
    ds_write_b32 v107, v11 offset:384
    v_pk_fma_f32 v[2:3], v[8:9], v[8:9], v[2:3]
    v_pk_fma_f32 v[2:3], v[10:11], v[10:11], v[2:3]
    v_mad_u32_u24 v107, v102, s66, v106
    v_mad_u32_u24 v107, v103, s65, v107
    v_pk_mov_b32 v[8:9], 0, 0
    v_pk_mov_b32 v[10:11], 0, 0
    s_mov_b64 exec, -1

k2_nofl_0:
    s_bitcmp1_b32 s57, s67
    s_cbranch_scc0 k2_nopr_0
    s_sub_u32 s56, s56, 1
    s_setprio 0
    s_cmp_eq_u32 s56, 0
    s_cbranch_scc1 k2_nopr_0
    s_setprio 1
    s_cmp_eq_u32 s56, 1
    s_cbranch_scc1 k2_nopr_0
    s_setprio 2

k2_nopr_0:
    s_mov_b32 s60, s67
    s_cmp_ge_u32 s60, s61

    s_cbranch_scc1 k2_main_done
k2_loop1:
    s_add_u32 s67, s60, 1
    s_bitcmp1_b32 s64, s67
    s_cbranch_scc0 k2_nob2_1
    s_add_u32 s44, s67, 32
    v_readlane_b32 s65, v101, s67
    v_readlane_b32 s66, v101, s44
    s_nop 1
    v_mad_u32_u24 v108, v102, s65, v104
    v_mad_u32_u24 v109, v102, s66, v105
    ds_read_b64_tr_b16 v[24:25], v108
    ds_read_b64_tr_b16 v[26:27], v109

k2_nob2_1:
    s_cmp_lg_u32 s55, 0
    s_cbranch_scc1 k2_w6_1
    s_waitcnt vmcnt(2) lgkmcnt(0)

k2_wd_1:
    v_mfma_f32_32x32x16_bf16 v[64:79], v[48:51], v[20:23], 0

    v_exp_f32 v32, v80
    v_exp_f32 v33, v81
    v_exp_f32 v34, v82
    v_exp_f32 v35, v83
    v_exp_f32 v36, v84
    v_mfma_f32_32x32x16_bf16 v[64:79], v[52:55], v[16:19], v[64:79]
    v_exp_f32 v37, v85
    v_exp_f32 v38, v86
    v_exp_f32 v39, v87
    v_exp_f32 v40, v88
    v_exp_f32 v41, v89
    v_mfma_f32_32x32x16_bf16 v[64:79], v[28:31], v[24:27], v[64:79]
    s_add_u32 s44, s60, 3
    s_cmp_lt_u32 s44, s61
    s_cselect_b32 s38, 10001, 0
    buffer_load_dwordx4 v[48:51], v[4:5], s[36:39], 0 idxen offen
    buffer_load_dwordx4 v[52:55], v[4:5], s[36:39], 0 idxen offen offset:128
    ds_read_b32 v6, v100 offset:320

    s_mov_b64 exec, s[70:71]
    ds_read_b32 v28, v110 offset:192
    s_mov_b64 exec, s[72:73]
    ds_read_b32 v29, v110 offset:192
    s_mov_b64 exec, s[74:75]
    ds_read_b32 v30, v110 offset:192
    s_mov_b64 exec, s[76:77]
    ds_read_b32 v31, v110 offset:192
    s_mov_b64 exec, -1
    s_cmp_eq_u32 s60, s54
    s_cbranch_scc1 k2_dma_1

k2_dmad_1:
    v_exp_f32 v42, v90
    v_exp_f32 v43, v91
    v_exp_f32 v44, v92
    v_exp_f32 v45, v93
    v_exp_f32 v46, v94
    v_exp_f32 v47, v95
    v_pk_add_f32 v[36:37], v[36:37], s[68:69]
    v_pk_add_f32 v[38:39], v[38:39], s[68:69]
    v_pk_add_f32 v[44:45], v[44:45], s[68:69]
    v_pk_add_f32 v[46:47], v[46:47], s[68:69]
    v_pk_fma_f32 v[112:113], v[84:85], v[32:33], v[84:85]
    v_pk_fma_f32 v[114:115], v[86:87], v[34:35], v[86:87]
    v_pk_fma_f32 v[32:33], v[32:33], v[36:37], v[36:37]
    v_pk_fma_f32 v[34:35], v[34:35], v[38:39], v[38:39]
    v_pk_fma_f32 v[112:113], v[80:81], v[36:37], v[112:113]
    v_pk_fma_f32 v[114:115], v[82:83], v[38:39], v[114:115]
    v_pk_fma_f32 v[36:37], v[92:93], v[40:41], v[92:93]
    v_pk_fma_f32 v[38:39], v[94:95], v[42:43], v[94:95]
    v_pk_fma_f32 v[40:41], v[40:41], v[44:45], v[44:45]
    v_pk_fma_f32 v[42:43], v[42:43], v[46:47], v[46:47]
    v_pk_fma_f32 v[36:37], v[88:89], v[44:45], v[36:37]
    v_pk_fma_f32 v[38:39], v[90:91], v[46:47], v[38:39]
    v_pk_mul_f32 v[44:45], v[32:33], v[40:41]
    v_pk_mul_f32 v[46:47], v[34:35], v[42:43]
    v_pk_mul_f32 v[112:113], v[112:113], v[40:41]
    v_pk_mul_f32 v[114:115], v[114:115], v[42:43]
    v_pk_fma_f32 v[112:113], v[36:37], v[32:33], v[112:113]
    v_pk_fma_f32 v[114:115], v[38:39], v[34:35], v[114:115]
    s_bitcmp1_b32 s64, s60
    s_cbranch_scc1 k2_nomrg1
    v_pk_mul_f32 v[112:113], v[112:113], v[12:13]
    v_pk_mul_f32 v[114:115], v[114:115], v[14:15]
    v_pk_fma_f32 v[112:113], v[96:97], v[44:45], v[112:113]
    v_pk_fma_f32 v[114:115], v[98:99], v[46:47], v[114:115]
    v_pk_mul_f32 v[44:45], v[44:45], v[12:13]
    v_pk_mul_f32 v[46:47], v[46:47], v[14:15]

k2_nomrg1:
    v_rcp_f32 v40, v44
    v_rcp_f32 v42, v46
    v_rcp_f32 v41, v45
    v_rcp_f32 v43, v47
    v_pk_fma_f32 v[2:3], v[44:45], v[46:47], v[2:3]
    v_pk_fma_f32 v[8:9], v[112:113], v[40:41], v[8:9]
    v_pk_fma_f32 v[10:11], v[114:115], v[42:43], v[10:11]
    s_bitcmp1_b32 s64, s67
    s_cbranch_scc0 k2_nofl_1

    s_bitcmp1_b32 s62, s67
    s_cselect_b32 exec_lo, -1, 0
    s_bitcmp1_b32 s63, s67
    s_cselect_b32 exec_hi, -1, 0
    ds_write_b32 v107, v8
    ds_write_b32 v107, v9 offset:128
    ds_write_b32 v107, v10 offset:256
    ds_write_b32 v107, v11 offset:384
    v_pk_fma_f32 v[2:3], v[8:9], v[8:9], v[2:3]
    v_pk_fma_f32 v[2:3], v[10:11], v[10:11], v[2:3]
    v_mad_u32_u24 v107, v102, s66, v106
    v_mad_u32_u24 v107, v103, s65, v107
    v_pk_mov_b32 v[8:9], 0, 0
    v_pk_mov_b32 v[10:11], 0, 0
    s_mov_b64 exec, -1

k2_nofl_1:
    s_bitcmp1_b32 s57, s67
    s_cbranch_scc0 k2_nopr_1
    s_sub_u32 s56, s56, 1
    s_setprio 0
    s_cmp_eq_u32 s56, 0
    s_cbranch_scc1 k2_nopr_1
    s_setprio 1
    s_cmp_eq_u32 s56, 1
    s_cbranch_scc1 k2_nopr_1
    s_setprio 2

k2_nopr_1:
    s_mov_b32 s60, s67
    s_cmp_ge_u32 s60, s61

    v_add_u32 v100, 128, v100
    v_add_u32 v110, 128, v110
    s_cbranch_scc0 k2_loop

    s_branch k2_main_done
k2_w6_0:
    s_waitcnt vmcnt(6) lgkmcnt(0)
    s_sub_u32 s55, s55, 1
    s_branch k2_wd_0

k2_dma_0:
    s_cmp_lt_u32 s3, 8
    s_cbranch_scc1 k2_dmag_0
    v_mov_b32 v116, 54532

k2_hspinh0:
    ds_read_b32 v117, v116
    s_waitcnt lgkmcnt(0)
    v_readfirstlane_b32 s44, v117
    s_cmp_lt_u32 s44, 16
    s_cbranch_scc1 k2_hspinh0
    v_and_b32 v120, 31, v1
    v_lshlrev_b32 v120, 2, v120
    ds_read_b32 v116, v120 offset:54800
    v_lshlrev_b32 v117, 3, v1
    s_mul_i32 s44, s3, 800
    s_add_u32 s45, s44, 71424
    v_add_u32 v118, s45, v117
    v_add_u32 v117, 109824, v117
    v_lshrrev_b32 v119, 2, v1
    v_xor_b32 v119, s3, v119
    v_lshlrev_b32 v119, 4, v119
    v_and_b32 v120, 3, v1
    v_lshl_add_u32 v119, v120, 2, v119
    s_lshl_b32 s45, s3, 8
    s_add_u32 s45, s45, 59136
    v_add_u32 v119, s45, v119
    s_waitcnt lgkmcnt(0)

    s_add_u32 s45, s44, 0
    v_cmp_eq_u32 vcc, s45, v116
    s_mov_b32 s50, vcc_lo
    s_ff1_i32_b32 s46, s50
    s_cmp_eq_u32 s50, 0
    s_cselect_b32 s46, 32, s46
    s_bitset0_b32 s50, s46
    s_lshl_b32 s46, s46, 9
    v_add_u32 v120, s46, v117

    s_add_u32 s45, s44, 12800
    v_cmp_eq_u32 vcc, s45, v116
    s_mov_b32 s51, vcc_lo
    s_ff1_i32_b32 s46, s51
    s_cmp_eq_u32 s51, 0
    s_cselect_b32 s46, 32, s46
    s_bitset0_b32 s51, s46
    s_lshl_b32 s46, s46, 9
    v_add_u32 v121, s46, v117

    s_add_u32 s45, s44, 25600
    v_cmp_eq_u32 vcc, s45, v116
    s_mov_b32 s52, vcc_lo
    s_ff1_i32_b32 s46, s52
    s_cmp_eq_u32 s52, 0
    s_cselect_b32 s46, 32, s46
    s_bitset0_b32 s52, s46
    s_lshl_b32 s46, s46, 9
    v_add_u32 v122, s46, v117

    s_mov_b32 s49, 1
    s_branch k2_dmad_0
k2_dmag_0:
    v_lshlrev_b32 v111, 4, v1
    buffer_load_dwordx4 v111, s[32:35], s53 offen offset:0 lds
    buffer_load_dwordx4 v111, s[32:35], s53 offen offset:1024 lds
    buffer_load_dwordx4 v111, s[32:35], s53 offen offset:2048 lds
    buffer_load_dwordx4 v111, s[32:35], s53 offen offset:3072 lds
    s_mov_b32 s55, 2
    s_mov_b32 s49, 1
    s_branch k2_dmad_0

k2_w6_1:
    s_waitcnt vmcnt(6) lgkmcnt(0)
    s_sub_u32 s55, s55, 1
    s_branch k2_wd_1

k2_dma_1:
    s_cmp_lt_u32 s3, 8
    s_cbranch_scc1 k2_dmag_1
    v_mov_b32 v116, 54532

k2_hspinh1:
    ds_read_b32 v117, v116
    s_waitcnt lgkmcnt(0)
    v_readfirstlane_b32 s44, v117
    s_cmp_lt_u32 s44, 16
    s_cbranch_scc1 k2_hspinh1
    v_and_b32 v120, 31, v1
    v_lshlrev_b32 v120, 2, v120
    ds_read_b32 v116, v120 offset:54800
    v_lshlrev_b32 v117, 3, v1
    s_mul_i32 s44, s3, 800
    s_add_u32 s45, s44, 71424
    v_add_u32 v118, s45, v117
    v_add_u32 v117, 109824, v117
    v_lshrrev_b32 v119, 2, v1
    v_xor_b32 v119, s3, v119
    v_lshlrev_b32 v119, 4, v119
    v_and_b32 v120, 3, v1
    v_lshl_add_u32 v119, v120, 2, v119
    s_lshl_b32 s45, s3, 8
    s_add_u32 s45, s45, 59136
    v_add_u32 v119, s45, v119
    s_waitcnt lgkmcnt(0)

    s_add_u32 s45, s44, 0
    v_cmp_eq_u32 vcc, s45, v116
    s_mov_b32 s50, vcc_lo
    s_ff1_i32_b32 s46, s50
    s_cmp_eq_u32 s50, 0
    s_cselect_b32 s46, 32, s46
    s_bitset0_b32 s50, s46
    s_lshl_b32 s46, s46, 9
    v_add_u32 v120, s46, v117

    s_add_u32 s45, s44, 12800
    v_cmp_eq_u32 vcc, s45, v116
    s_mov_b32 s51, vcc_lo
    s_ff1_i32_b32 s46, s51
    s_cmp_eq_u32 s51, 0
    s_cselect_b32 s46, 32, s46
    s_bitset0_b32 s51, s46
    s_lshl_b32 s46, s46, 9
    v_add_u32 v121, s46, v117

    s_add_u32 s45, s44, 25600
    v_cmp_eq_u32 vcc, s45, v116
    s_mov_b32 s52, vcc_lo
    s_ff1_i32_b32 s46, s52
    s_cmp_eq_u32 s52, 0
    s_cselect_b32 s46, 32, s46
    s_bitset0_b32 s52, s46
    s_lshl_b32 s46, s46, 9
    v_add_u32 v122, s46, v117

    s_mov_b32 s49, 1
    s_branch k2_dmad_1
k2_dmag_1:
    v_lshlrev_b32 v111, 4, v1
    buffer_load_dwordx4 v111, s[32:35], s53 offen offset:0 lds
    buffer_load_dwordx4 v111, s[32:35], s53 offen offset:1024 lds
    buffer_load_dwordx4 v111, s[32:35], s53 offen offset:2048 lds
    buffer_load_dwordx4 v111, s[32:35], s53 offen offset:3072 lds
    s_mov_b32 s55, 2
    s_mov_b32 s49, 1
    s_branch k2_dmad_1

k2_main_done:
    s_setprio 0
    s_mov_b32 s44, 0x7b800000
    v_cmp_nlt_f32 vcc, v2, s44
    v_cmp_nlt_f32 s[46:47], v3, s44
    s_or_b64 vcc, vcc, s[46:47]
    s_cbranch_vccz k2_mon_ok
    v_mov_b32 v100, 54528
    v_mov_b32 v101, 1
    s_mov_b64 exec, 1
    ds_or_b32 v100, v101
    s_mov_b64 exec, -1

k2_mon_ok:
    s_mov_b32 s40, s16
    s_and_b32 s41, s17, 0xffff
    s_mov_b32 s42, 2560000
    s_mov_b32 s43, 0x20000
    s_cmp_lt_u32 s3, 8
    s_cbranch_scc1 k2_fp_full
    s_cmp_eq_u32 s49, 1
    s_cbranch_scc0 k2_fp_full

    v_mov_b32 v101, v117
    v_mov_b32 v102, v118
    v_mov_b32 v103, v119
    v_mov_b32 v104, v120
    v_mov_b32 v105, v121
    v_mov_b32 v106, v122
    s_branch k2_fin_bar
k2_fp_full:
    v_mov_b32 v100, 54532

k2_hspin:
    ds_read_b32 v101, v100
    s_waitcnt lgkmcnt(0)
    v_readfirstlane_b32 s44, v101
    s_cmp_lt_u32 s44, 16
    s_cbranch_scc1 k2_hspin
    v_and_b32 v104, 31, v1
    v_lshlrev_b32 v104, 2, v104
    ds_read_b32 v100, v104 offset:54800
    v_lshlrev_b32 v101, 3, v1
    s_mul_i32 s44, s3, 800
    s_add_u32 s45, s44, 71424
    v_add_u32 v102, s45, v101
    v_add_u32 v101, 109824, v101
    v_lshrrev_b32 v103, 2, v1
    v_xor_b32 v103, s3, v103
    v_lshlrev_b32 v103, 4, v103
    v_and_b32 v104, 3, v1
    v_lshl_add_u32 v103, v104, 2, v103
    s_lshl_b32 s45, s3, 8
    s_add_u32 s45, s45, 59136
    v_add_u32 v103, s45, v103
    s_waitcnt lgkmcnt(0)

    s_add_u32 s45, s44, 0
    v_cmp_eq_u32 vcc, s45, v100
    s_mov_b32 s50, vcc_lo
    s_ff1_i32_b32 s46, s50
    s_cmp_eq_u32 s50, 0
    s_cselect_b32 s46, 32, s46
    s_bitset0_b32 s50, s46
    s_lshl_b32 s46, s46, 9
    v_add_u32 v104, s46, v101

    s_add_u32 s45, s44, 12800
    v_cmp_eq_u32 vcc, s45, v100
    s_mov_b32 s51, vcc_lo
    s_ff1_i32_b32 s46, s51
    s_cmp_eq_u32 s51, 0
    s_cselect_b32 s46, 32, s46
    s_bitset0_b32 s51, s46
    s_lshl_b32 s46, s46, 9
    v_add_u32 v105, s46, v101

    s_add_u32 s45, s44, 25600
    v_cmp_eq_u32 vcc, s45, v100
    s_mov_b32 s52, vcc_lo
    s_ff1_i32_b32 s46, s52
    s_cmp_eq_u32 s52, 0
    s_cselect_b32 s46, 32, s46
    s_bitset0_b32 s52, s46
    s_lshl_b32 s46, s46, 9
    v_add_u32 v106, s46, v101

    s_cmp_lt_u32 s3, 8
    s_cbranch_scc0 k2_fin_bar

    s_add_u32 s32, s20, 2621440
    s_addc_u32 s33, s21, 0
    s_and_b32 s33, s33, 0xffff
    s_mov_b32 s34, 98304
    s_mov_b32 s35, 0x20000
    v_lshlrev_b32 v5, 4, v1
    s_cmp_eq_u32 s49, 0
    s_cbranch_scc0 k2_dma_ok
    s_lshl_b32 s44, s3, 12
    s_add_u32 s45, s44, 65536
    s_add_u32 s44, s44, 126720
    s_mov_b32 m0, s44
    s_nop 0

    buffer_load_dwordx4 v5, s[32:35], s45 offen offset:0 lds
    buffer_load_dwordx4 v5, s[32:35], s45 offen offset:1024 lds
    buffer_load_dwordx4 v5, s[32:35], s45 offen offset:2048 lds
    buffer_load_dwordx4 v5, s[32:35], s45 offen offset:3072 lds
k2_dma_ok:
    s_waitcnt vmcnt(0)
    s_add_u32 s44, s3, 8
    s_lshl_b32 s44, s44, 12

    buffer_load_dwordx4 v[80:83], v5, s[32:35], s44 offen offset:0
    buffer_load_dwordx4 v[84:87], v5, s[32:35], s44 offen offset:1024
    buffer_load_dwordx4 v[88:91], v5, s[32:35], s44 offen offset:2048
    buffer_load_dwordx4 v[92:95], v5, s[32:35], s44 offen offset:3072
    s_lshl_b32 s44, s3, 12
    s_add_u32 s44, s44, 126720
    v_add_u32 v5, s44, v5
    ds_read_b128 v[16:19], v5
    ds_read_b128 v[20:23], v5 offset:1024
    ds_read_b128 v[24:27], v5 offset:2048
    ds_read_b128 v[28:31], v5 offset:3072
    v_and_b32 v6, 15, v1
    v_lshrrev_b32 v7, 4, v1
    v_xor_b32 v8, v7, v6
    v_lshlrev_b32 v8, 4, v8
    v_lshl_add_u32 v8, v6, 8, v8
    v_add_u32 v8, 59136, v8
    v_xor_b32 v9, 64, v8
    v_xor_b32 v10, 0x80, v8
    v_xor_b32 v11, 0xc0, v8

    ds_read_b128 v[32:35], v8 offset:0
    ds_read_b128 v[36:39], v9 offset:0
    ds_read_b128 v[40:43], v10 offset:0
    ds_read_b128 v[44:47], v11 offset:0
    ds_read_b128 v[48:51], v8 offset:4096
    ds_read_b128 v[52:55], v9 offset:4096
    ds_read_b128 v[56:59], v10 offset:4096
    ds_read_b128 v[60:63], v11 offset:4096
    ds_read_b128 v[64:67], v8 offset:8192
    ds_read_b128 v[68:71], v9 offset:8192
    ds_read_b128 v[72:75], v10 offset:8192
    ds_read_b128 v[76:79], v11 offset:8192
    v_add_u32 v2, s22, v6
    v_lshlrev_b32 v2, 8, v2
    v_lshl_add_u32 v2, v7, 3, v2
    s_lshl_b32 s44, s3, 5
    v_add_u32 v2, s44, v2
    v_add_u32 v3, 32, v6
    s_waitcnt vmcnt(0) lgkmcnt(0)

    v_mfma_f32_16x16x32_bf16 v[116:119], v[80:83], v[32:35], 0
    v_mfma_f32_16x16x32_bf16 v[116:119], v[84:87], v[36:39], v[116:119]
    v_mfma_f32_16x16x32_bf16 v[116:119], v[88:91], v[40:43], v[116:119]
    v_mfma_f32_16x16x32_bf16 v[116:119], v[92:95], v[44:47], v[116:119]
    v_mfma_f32_16x16x32_bf16 v[120:123], v[80:83], v[48:51], 0
    v_mfma_f32_16x16x32_bf16 v[120:123], v[84:87], v[52:55], v[120:123]
    v_mfma_f32_16x16x32_bf16 v[120:123], v[88:91], v[56:59], v[120:123]
    v_mfma_f32_16x16x32_bf16 v[120:123], v[92:95], v[60:63], v[120:123]
    v_mfma_f32_16x16x32_bf16 v[124:127], v[80:83], v[64:67], 0
    v_mfma_f32_16x16x32_bf16 v[124:127], v[84:87], v[68:71], v[124:127]
    v_mfma_f32_16x16x32_bf16 v[124:127], v[88:91], v[72:75], v[124:127]
    v_mfma_f32_16x16x32_bf16 v[124:127], v[92:95], v[76:79], v[124:127]
k2_fin_bar:
    s_mov_b32 s56, 0xbf317218
    s_mov_b32 s57, 0xbf317218
    v_mov_b32 v35, 54528
    s_waitcnt lgkmcnt(0)
    s_barrier

    ds_read_b32 v35, v35
    ds_read_b64 v[36:37], v102
    ds_read_b64 v[42:43], v104
    ds_read_b64 v[38:39], v102 offset:12800
    ds_read_b64 v[44:45], v105
    ds_read_b64 v[40:41], v102 offset:25600
    ds_read_b64 v[46:47], v106

    s_or_b32 s46, s50, s51
    s_or_b32 s46, s46, s52
    s_waitcnt lgkmcnt(6)
    v_readfirstlane_b32 s47, v35

    s_waitcnt lgkmcnt(4)
    v_pk_add_f32 v[36:37], v[36:37], v[42:43]
    s_waitcnt lgkmcnt(2)
    v_pk_add_f32 v[38:39], v[38:39], v[44:45]
    s_waitcnt lgkmcnt(0)
    v_pk_add_f32 v[40:41], v[40:41], v[46:47]
    s_cmp_eq_u32 s47, 0
    s_cbranch_scc0 k2_slow
    s_cmp_eq_u32 s46, 0
    s_cbranch_scc0 k2_moreheads

k2_cvt:
    v_pk_mul_f32 v[36:37], v[36:37], s[56:57]
    v_pk_mul_f32 v[38:39], v[38:39], s[56:57]
    v_pk_mul_f32 v[40:41], v[40:41], s[56:57]
    v_cvt_pk_bf16_f32 v42, v36, v37
    ds_write_b32 v103, v42 offset:0
    v_cvt_pk_bf16_f32 v43, v38, v39
    ds_write_b32 v103, v43 offset:4096
    v_cvt_pk_bf16_f32 v44, v40, v41
    ds_write_b32 v103, v44 offset:8192
    s_mov_b32 s44, 0xbfb8aa3b
    s_mov_b32 s45, 0xbfb8aa3b
    s_waitcnt lgkmcnt(0)
    s_barrier

    s_cmp_lt_u32 s3, 8
    s_cbranch_scc0 k2_end2

    ds_read_b128 v[64:67], v8 offset:0
    ds_read_b128 v[68:71], v9 offset:0
    ds_read_b128 v[72:75], v10 offset:0
    ds_read_b128 v[76:79], v11 offset:0
    ds_read_b128 v[80:83], v8 offset:4096
    ds_read_b128 v[84:87], v9 offset:4096
    ds_read_b128 v[88:91], v10 offset:4096
    ds_read_b128 v[92:95], v11 offset:4096
    ds_read_b128 v[96:99], v8 offset:8192
    ds_read_b128 v[100:103], v9 offset:8192
    ds_read_b128 v[104:107], v10 offset:8192
    ds_read_b128 v[108:111], v11 offset:8192
    v_cmp_gt_u32 vcc, s23, v3
    s_waitcnt lgkmcnt(8)
    v_mfma_f32_16x16x32_bf16 v[116:119], v[16:19], v[64:67], v[116:119]
    v_mfma_f32_16x16x32_bf16 v[116:119], v[20:23], v[68:71], v[116:119]
    v_mfma_f32_16x16x32_bf16 v[116:119], v[24:27], v[72:75], v[116:119]
    v_mfma_f32_16x16x32_bf16 v[116:119], v[28:31], v[76:79], v[116:119]
    s_waitcnt lgkmcnt(4)
    v_mfma_f32_16x16x32_bf16 v[120:123], v[16:19], v[80:83], v[120:123]
    v_mfma_f32_16x16x32_bf16 v[120:123], v[20:23], v[84:87], v[120:123]
    v_mfma_f32_16x16x32_bf16 v[120:123], v[24:27], v[88:91], v[120:123]
    v_mfma_f32_16x16x32_bf16 v[120:123], v[28:31], v[92:95], v[120:123]
    s_waitcnt lgkmcnt(0)
    v_mfma_f32_16x16x32_bf16 v[124:127], v[16:19], v[96:99], v[124:127]
    v_mfma_f32_16x16x32_bf16 v[124:127], v[20:23], v[100:103], v[124:127]
    v_mfma_f32_16x16x32_bf16 v[124:127], v[24:27], v[104:107], v[124:127]
    v_mfma_f32_16x16x32_bf16 v[124:127], v[28:31], v[108:111], v[124:127]
    s_nop 1
    v_pk_mul_f32 v[32:33], v[116:117], s[44:45]
    v_pk_mul_f32 v[34:35], v[118:119], s[44:45]
    v_exp_f32 v32, v32
    v_exp_f32 v33, v33
    v_exp_f32 v34, v34
    v_exp_f32 v35, v35
    v_pk_mul_f32 v[36:37], v[120:121], s[44:45]
    v_pk_mul_f32 v[38:39], v[122:123], s[44:45]
    v_exp_f32 v36, v36
    v_exp_f32 v37, v37
    v_exp_f32 v38, v38
    v_exp_f32 v39, v39
    v_pk_add_f32 v[32:33], v[32:33], s[68:69]
    v_pk_add_f32 v[34:35], v[34:35], s[68:69]
    v_rcp_f32 v32, v32
    v_rcp_f32 v33, v33
    v_rcp_f32 v34, v34
    v_rcp_f32 v35, v35
    v_pk_mul_f32 v[40:41], v[124:125], s[44:45]
    v_pk_mul_f32 v[42:43], v[126:127], s[44:45]
    v_exp_f32 v40, v40
    v_exp_f32 v41, v41
    v_exp_f32 v42, v42
    v_exp_f32 v43, v43
    s_nop 0
    v_pk_mul_f32 v[32:33], v[32:33], v[116:117]
    v_pk_mul_f32 v[34:35], v[34:35], v[118:119]
    v_cvt_pk_bf16_f32 v32, v32, v33
    v_cvt_pk_bf16_f32 v33, v34, v35
    s_mov_b32 s56, 0
    buffer_store_dwordx2 v[32:33], v2, s[40:43], s56 offen
    v_pk_add_f32 v[36:37], v[36:37], s[68:69]
    v_pk_add_f32 v[38:39], v[38:39], s[68:69]
    v_rcp_f32 v36, v36
    v_rcp_f32 v37, v37
    v_rcp_f32 v38, v38
    v_rcp_f32 v39, v39
    v_pk_add_f32 v[40:41], v[40:41], s[68:69]
    v_pk_add_f32 v[42:43], v[42:43], s[68:69]
    v_rcp_f32 v40, v40
    v_rcp_f32 v41, v41
    v_rcp_f32 v42, v42
    v_rcp_f32 v43, v43
    v_pk_mul_f32 v[36:37], v[36:37], v[120:121]
    v_pk_mul_f32 v[38:39], v[38:39], v[122:123]
    v_cvt_pk_bf16_f32 v36, v36, v37
    v_cvt_pk_bf16_f32 v37, v38, v39
    s_mov_b32 s56, 4096
    buffer_store_dwordx2 v[36:37], v2, s[40:43], s56 offen
    v_pk_mul_f32 v[40:41], v[40:41], v[124:125]
    v_pk_mul_f32 v[42:43], v[42:43], v[126:127]
    v_cvt_pk_bf16_f32 v40, v40, v41
    v_cvt_pk_bf16_f32 v41, v42, v43
    s_mov_b64 exec, vcc
    s_mov_b32 s56, 8192
    buffer_store_dwordx2 v[40:41], v2, s[40:43], s56 offen
k2_end2:
    s_endpgm
k2_moreheads:
k2_more0:
    s_cmp_eq_u32 s50, 0
    s_cbranch_scc1 k2_nomore0
    s_ff1_i32_b32 s46, s50
    s_bitset0_b32 s50, s46
    s_lshl_b32 s46, s46, 9
    v_add_u32 v35, s46, v101
    ds_read_b64 v[42:43], v35
    s_waitcnt lgkmcnt(0)
    v_pk_add_f32 v[36:37], v[36:37], v[42:43]
    s_branch k2_more0

k2_nomore0:
k2_more1:
    s_cmp_eq_u32 s51, 0
    s_cbranch_scc1 k2_nomore1
    s_ff1_i32_b32 s46, s51
    s_bitset0_b32 s51, s46
    s_lshl_b32 s46, s46, 9
    v_add_u32 v35, s46, v101
    ds_read_b64 v[42:43], v35
    s_waitcnt lgkmcnt(0)
    v_pk_add_f32 v[38:39], v[38:39], v[42:43]
    s_branch k2_more1

k2_nomore1:
k2_more2:
    s_cmp_eq_u32 s52, 0
    s_cbranch_scc1 k2_nomore2
    s_ff1_i32_b32 s46, s52
    s_bitset0_b32 s52, s46
    s_lshl_b32 s46, s46, 9
    v_add_u32 v35, s46, v101
    ds_read_b64 v[42:43], v35
    s_waitcnt lgkmcnt(0)
    v_pk_add_f32 v[40:41], v[40:41], v[42:43]
    s_branch k2_more2

k2_nomore2:
    s_branch k2_cvt
k2_A_G:
    v_lshrrev_b32 v108, 4, v0
    v_xor_b32 v109, v108, v0
    v_and_b32 v109, 15, v109
    v_lshlrev_b32 v109, 4, v109
    v_lshl_add_u32 v109, v108, 8, v109
    v_add_u32 v96, 59136, v109
    s_cmp_lg_u32 s52, 0
    s_cbranch_scc1 k2_xw_pf
    s_waitcnt vmcnt(5)
    s_branch k2_xw_go

k2_xw_pf:
    s_waitcnt vmcnt(5)
k2_xw_go:
    ds_write_b128 v96, v[24:27]
    s_cmp_lt_u32 s3, 4
    s_cbranch_scc0 k2_g_nox2
    ds_write_b128 v96, v[28:31] offset:8192

k2_g_nox2:
    s_cmp_eq_u32 s3, 7
    s_cbranch_scc0 k2_g_now3
    s_waitcnt vmcnt(0)
    v_lshlrev_b32 v97, 16, v99
    v_and_b32 v98, 0xffff0000, v99
    v_mul_f32 v97, 0xbfb8aa3b, v97
    v_mul_f32 v98, 0xbfb8aa3b, v98
    v_cvt_pk_bf16_f32 v99, v97, v98
    v_lshlrev_b32 v96, 16, v99
    v_and_b32 v100, 0xffff0000, v99
    v_sub_f32 v97, v97, v96
    v_sub_f32 v98, v98, v100
    v_cvt_pk_bf16_f32 v96, v97, v98
    ds_write_b32 v2, v99 offset:55040
    ds_write_b32 v2, v96 offset:55296

k2_g_now3:
    s_waitcnt lgkmcnt(0)
    s_barrier

    v_and_b32 v8, 15, v1
    v_lshrrev_b32 v9, 4, v1
    v_xor_b32 v10, v9, v8
    v_lshlrev_b32 v10, 4, v10
    v_lshl_add_u32 v10, v8, 8, v10
    v_add_u32 v10, 59136, v10
    v_xor_b32 v11, 64, v10
    v_xor_b32 v108, 0x80, v10
    v_xor_b32 v109, 0xc0, v10

    ds_read_b128 v[64:67], v10 offset:0
    ds_read_b128 v[68:71], v11 offset:0
    ds_read_b128 v[72:75], v108 offset:0
    ds_read_b128 v[76:79], v109 offset:0
    ds_read_b128 v[80:83], v10 offset:4096
    ds_read_b128 v[84:87], v11 offset:4096
    ds_read_b128 v[88:91], v108 offset:4096
    ds_read_b128 v[92:95], v109 offset:4096
    s_waitcnt vmcnt(0) lgkmcnt(4)
    v_mfma_f32_16x16x32_bf16 v[24:27], v[32:35], v[64:67], 0
    v_mfma_f32_16x16x32_bf16 v[24:27], v[36:39], v[68:71], v[24:27]
    v_mfma_f32_16x16x32_bf16 v[24:27], v[40:43], v[72:75], v[24:27]
    v_mfma_f32_16x16x32_bf16 v[24:27], v[44:47], v[76:79], v[24:27]
    ds_read_b128 v[64:67], v10 offset:8192
    ds_read_b128 v[68:71], v11 offset:8192
    ds_read_b128 v[72:75], v108 offset:8192
    ds_read_b128 v[76:79], v109 offset:8192
    s_waitcnt lgkmcnt(4)
    v_mfma_f32_16x16x32_bf16 v[28:31], v[32:35], v[80:83], 0
    v_mfma_f32_16x16x32_bf16 v[28:31], v[36:39], v[84:87], v[28:31]
    v_mfma_f32_16x16x32_bf16 v[28:31], v[40:43], v[88:91], v[28:31]
    v_mfma_f32_16x16x32_bf16 v[28:31], v[44:47], v[92:95], v[28:31]
    s_waitcnt lgkmcnt(0)
    v_mfma_f32_16x16x32_bf16 v[112:115], v[32:35], v[64:67], 0
    v_mfma_f32_16x16x32_bf16 v[112:115], v[36:39], v[68:71], v[112:115]
    v_mfma_f32_16x16x32_bf16 v[112:115], v[40:43], v[72:75], v[112:115]
    v_mfma_f32_16x16x32_bf16 v[112:115], v[44:47], v[76:79], v[112:115]
    v_mov_b32 v11, 800
    v_mul_u32_u24 v10, v8, v11
    v_lshl_add_u32 v10, v9, 3, v10
    s_lshl_b32 s44, s3, 5
    s_add_u32 s44, s44, 71952
    v_add_u32 v10, s44, v10
    s_mov_b32 s44, 0xbfb8aa3b
    s_mov_b32 s45, 0xbfb8aa3b

    v_pk_mul_f32 v[24:25], v[24:25], s[44:45]
    v_pk_mul_f32 v[26:27], v[26:27], s[44:45]
    v_cvt_pk_bf16_f32 v24, v24, v25
    v_cvt_pk_bf16_f32 v25, v26, v27
    ds_write_b64 v10, v[24:25] offset:0
    v_pk_mul_f32 v[28:29], v[28:29], s[44:45]
    v_pk_mul_f32 v[30:31], v[30:31], s[44:45]
    v_cvt_pk_bf16_f32 v28, v28, v29
    v_cvt_pk_bf16_f32 v29, v30, v31
    ds_write_b64 v10, v[28:29] offset:12800
    s_nop 1
    v_pk_mul_f32 v[112:113], v[112:113], s[44:45]
    v_pk_mul_f32 v[114:115], v[114:115], s[44:45]
    v_cvt_pk_bf16_f32 v112, v112, v113
    v_cvt_pk_bf16_f32 v113, v114, v115
    ds_write_b64 v10, v[112:113] offset:25600
    s_waitcnt lgkmcnt(0)
    v_mov_b32 v96, 54536
    v_mov_b32 v97, 1
    s_mov_b64 exec, 1
    ds_add_u32 v96, v97
    s_mov_b64 exec, -1

    v_mov_b32 v24, 54928
    ds_read_b32 v24, v24
    s_waitcnt lgkmcnt(0)
    v_readfirstlane_b32 s60, v24

    s_lshr_b32 s60, s60, 2
    s_add_u32 s60, s60, 1
    s_lshr_b32 s60, s60, 1
    s_cmp_gt_u32 s60, 8
    s_cselect_b32 s46, 4, 0
    s_sub_u32 s47, s60, s46
    s_mul_i32 s44, s3, s47
    s_add_u32 s45, s44, s47
    s_lshl_b32 s46, s46, 1
    s_sub_i32 s48, s3, 8
    s_max_i32 s48, s48, 0
    s_mul_i32 s48, s48, s46
    s_add_u32 s44, s44, s48
    s_sub_i32 s48, s3, 7
    s_max_i32 s48, s48, 0
    s_mul_i32 s48, s48, s46
    s_add_u32 s45, s45, s48
    s_lshr_b32 s44, s44, 4
    s_lshr_b32 s45, s45, 4
    s_sub_u32 s61, s45, s44
    s_lshl_b32 s59, s44, 1
    v_and_b32 v109, 31, v1
    v_mul_u32_u24 v101, s61, v102
    v_add3_u32 v101, v101, v109, s59
    v_lshlrev_b32 v101, 2, v101
    v_add_u32 v108, -4, v101
    v_max_i32 v108, 0, v108
    v_bfe_u32 v109, v1, 2, 1
    v_mul_u32_u24 v100, s61, v109
    v_add_u32 v100, s59, v100
    v_bfe_u32 v109, v1, 3, 2
    v_lshl_add_u32 v100, v100, 2, v109
    v_lshlrev_b32 v100, 4, v100
    v_and_b32 v109, 1, v1
    v_lshl_add_u32 v109, v109, 2, 4
    v_mad_u32_u24 v110, v109, v102, v100
    v_add_u32 v110, 4, v110
    s_lshl_b32 s45, s3, 10
    s_add_u32 s45, s45, 38400
    v_lshl_add_u32 v107, v102, 9, v106
    v_add_u32 v107, s45, v107

    s_branch k2_main
k2_setflag:
    v_mov_b32 v120, 54528
    v_mov_b32 v121, 2
    s_mov_b64 exec, 1
    ds_or_b32 v120, v121
    s_mov_b64 exec, -1
    s_branch k2_noflag

k2_slow:
    s_mov_b32 s84, s47
    s_bitcmp1_b32 s84, 0
    s_cbranch_scc0 k2_slow_sum
    s_waitcnt vmcnt(0) lgkmcnt(0)
    s_barrier
    v_lshrrev_b32 v102, 5, v1
    v_and_b32 v108, 3, v1
    v_lshlrev_b32 v5, 6, v102
    v_lshl_add_u32 v5, v108, 4, v5
    v_mov_b32 v7, v5
    v_bfe_u32 v106, v1, 2, 1
    v_lshlrev_b32 v106, 6, v106
    v_bfe_u32 v110, v1, 4, 1
    v_lshl_add_u32 v106, v110, 5, v106
    v_bfe_u32 v111, v1, 3, 1
    v_lshl_add_u32 v106, v111, 4, v106
    v_lshl_add_u32 v106, v108, 2, v106
    v_add_u32 v106, 71424, v106

    v_mov_b32 v108, 0x3f800000
    v_mov_b32 v109, 0x3f80
    s_mov_b32 s44, 0xaaaaaaaa
    s_mov_b32 s45, 0xaaaaaaaa
    v_cndmask_b32 v111, v109, v108, s[44:45]

    s_mov_b32 s44, 0x3
    s_mov_b32 s45, 0x300
    v_cndmask_b32 v20, 0, v111, s[44:45]
    s_mov_b32 s44, 0x30000
    s_mov_b32 s45, 0x3000000
    v_cndmask_b32 v16, 0, v111, s[44:45]
    s_mov_b32 s44, 0xc
    s_mov_b32 s45, 0xc00
    v_cndmask_b32 v21, 0, v111, s[44:45]
    s_mov_b32 s44, 0xc0000
    s_mov_b32 s45, 0xc000000
    v_cndmask_b32 v17, 0, v111, s[44:45]
    s_mov_b32 s44, 0x30
    s_mov_b32 s45, 0x3000
    v_cndmask_b32 v22, 0, v111, s[44:45]
    s_mov_b32 s44, 0x300000
    s_mov_b32 s45, 0x30000000
    v_cndmask_b32 v18, 0, v111, s[44:45]
    s_mov_b32 s44, 0xc0
    s_mov_b32 s45, 0xc000
    v_cndmask_b32 v23, 0, v111, s[44:45]
    s_mov_b32 s44, 0xc00000
    s_mov_b32 s45, 0xc0000000
    v_cndmask_b32 v19, 0, v111, s[44:45]
    v_sub_u32 v103, 1, v102
    v_and_b32 v109, 1, v1
    v_lshlrev_b32 v109, 5, v109
    v_bfe_u32 v110, v1, 4, 1
    v_lshl_add_u32 v109, v110, 4, v109
    v_bfe_u32 v111, v1, 1, 1
    v_lshl_add_u32 v109, v111, 3, v109
    v_bfe_u32 v111, v1, 2, 2
    v_and_b32 v104, 1, v111
    v_lshlrev_b32 v104, 8, v104
    v_lshrrev_b32 v105, 1, v111
    v_lshl_add_u32 v104, v105, 6, v104
    v_add_u32 v104, 55040, v104
    v_lshlrev_b32 v105, 6, v111
    v_add_u32 v105, 71952, v105
    s_mov_b32 s44, 0
    s_mov_b32 s45, -1
    v_cndmask_b32 v104, v104, v105, s[44:45]
    v_add_u32 v104, v104, v109
    v_lshl_add_u32 v105, v103, 7, v104
    s_mov_b32 s68, 1.0
    s_mov_b32 s69, 1.0

    v_mov_b32 v24, 54928
    ds_read_b32 v24, v24
    s_waitcnt lgkmcnt(0)
    v_readfirstlane_b32 s60, v24

    s_lshr_b32 s60, s60, 2
    s_add_u32 s60, s60, 1
    s_lshr_b32 s60, s60, 1
    s_cmp_gt_u32 s60, 8
    s_cselect_b32 s46, 4, 0
    s_sub_u32 s47, s60, s46
    s_mul_i32 s44, s3, s47
    s_add_u32 s45, s44, s47
    s_lshl_b32 s46, s46, 1
    s_sub_i32 s48, s3, 8
    s_max_i32 s48, s48, 0
    s_mul_i32 s48, s48, s46
    s_add_u32 s44, s44, s48
    s_sub_i32 s48, s3, 7
    s_max_i32 s48, s48, 0
    s_mul_i32 s48, s48, s46
    s_add_u32 s45, s45, s48
    s_lshr_b32 s44, s44, 4
    s_lshr_b32 s45, s45, 4
    s_sub_u32 s61, s45, s44
    s_lshl_b32 s59, s44, 1
    v_and_b32 v109, 31, v1
    v_mul_u32_u24 v101, s61, v102
    v_add3_u32 v101, v101, v109, s59
    v_lshlrev_b32 v101, 2, v101
    v_add_u32 v108, -4, v101
    v_max_i32 v108, 0, v108
    v_bfe_u32 v109, v1, 2, 1
    v_mul_u32_u24 v100, s61, v109
    v_add_u32 v100, s59, v100
    v_bfe_u32 v109, v1, 3, 2
    v_lshl_add_u32 v100, v100, 2, v109
    v_lshlrev_b32 v100, 4, v100
    v_and_b32 v109, 1, v1
    v_lshl_add_u32 v109, v109, 2, 4
    v_mad_u32_u24 v110, v109, v102, v100
    v_add_u32 v110, 4, v110
    s_lshl_b32 s45, s3, 10
    s_add_u32 s45, s45, 38400
    v_lshl_add_u32 v107, v102, 9, v106
    v_add_u32 v107, s45, v107

    ds_read_b32 v4, v100
    ds_read_b32 v109, v101 offset:55552
    ds_read_b32 v108, v108 offset:55552
    ds_read_b32 v6, v100 offset:64
    v_mov_b32 v28, 0
    v_mov_b32 v29, 0
    v_mov_b32 v30, 0
    v_mov_b32 v31, 0

    s_mov_b32 s70, 0x11111111
    s_mov_b32 s71, 0x3030303
    s_mov_b32 s72, 0x22222222
    s_mov_b32 s73, 0xc0c0c0c
    s_mov_b32 s74, 0x44444444
    s_mov_b32 s75, 0x30303030
    s_mov_b32 s76, 0x88888888
    s_mov_b32 s77, 0xc0c0c0c0
    s_mov_b64 exec, s[70:71]
    ds_read_b32 v28, v110 offset:0
    s_mov_b64 exec, s[72:73]
    ds_read_b32 v29, v110 offset:0
    s_mov_b64 exec, s[74:75]
    ds_read_b32 v30, v110 offset:0
    s_mov_b64 exec, s[76:77]
    ds_read_b32 v31, v110 offset:0
    s_mov_b64 exec, -1
    s_mov_b32 s36, s20
    s_and_b32 s37, s21, 0xffff
    s_or_b32 s37, s37, 16777216
    s_mov_b32 s38, 10001
    s_mov_b32 s39, 0x20000
    s_mov_b32 s49, 0
    s_cmp_gt_u32 s61, 0
    s_cselect_b32 s38, 10001, 0
    s_waitcnt lgkmcnt(7)
    buffer_load_dwordx4 v[48:51], v[4:5], s[36:39], 0 idxen offen
    buffer_load_dwordx4 v[52:55], v[4:5], s[36:39], 0 idxen offen offset:128

    s_waitcnt lgkmcnt(4)
    v_mov_b32 v101, v109
    v_cmp_ne_u32 vcc, v108, v109
    ds_read_b32 v4, v100 offset:128
    s_lshl_b32 s45, s3, 3
    v_lshl_add_u32 v111, v102, 2, s45
    v_mov_b32 v108, v101
    s_mov_b32 s62, vcc_lo
    s_mov_b32 s63, vcc_hi
    s_cmp_eq_u32 s61, 0
    s_cbranch_scc0 k2_hns
    v_mov_b32 v108, -1

k2_hns:
    s_mov_b32 exec_lo, 1
    s_mov_b32 exec_hi, 1
    ds_write_b32 v111, v108 offset:54800
    s_mov_b32 exec_hi, 0
    v_mov_b32 v108, 54532
    v_mov_b32 v109, 1
    ds_add_u32 v108, v109
    s_mov_b64 exec, -1
    s_lshl_b32 s44, 1, s61
    s_or_b32 s62, s62, s44
    s_or_b32 s63, s63, s44
    s_or_b32 s64, s62, s63
    s_mov_b32 s44, 32
    v_readlane_b32 s65, v101, 0
    v_readlane_b32 s66, v101, s44
    v_mov_b32 v111, 54536

k2_qspins:
    ds_read_b32 v108, v111
    s_waitcnt lgkmcnt(0)
    v_readfirstlane_b32 s44, v108
    s_cmp_lt_u32 s44, 8
    s_cbranch_scc1 k2_qspins
    s_cmp_gt_u32 s61, 1
    s_cselect_b32 s38, 10001, 0
    v_mad_u32_u24 v108, v102, s65, v104
    v_mad_u32_u24 v109, v102, s66, v105
    ds_read_b64_tr_b16 v[24:25], v108
    ds_read_b64_tr_b16 v[26:27], v109
    buffer_load_dwordx4 v[56:59], v[6:7], s[36:39], 0 idxen offen
    buffer_load_dwordx4 v[60:63], v[6:7], s[36:39], 0 idxen offen offset:128
    ds_read_b32 v6, v100 offset:192
    v_mov_b32 v8, 0
    v_mov_b32 v9, 0
    v_mov_b32 v10, 0
    v_mov_b32 v11, 0
    v_mov_b32 v2, 0
    v_mov_b32 v3, 0
    s_cmp_eq_u32 s61, 0
    s_cbranch_scc1 k2_main_dones
    s_waitcnt lgkmcnt(0)
    s_waitcnt vmcnt(2)

    v_mfma_f32_32x32x16_bf16 v[64:79], v[48:51], v[20:23], 0
    v_mfma_f32_32x32x16_bf16 v[64:79], v[52:55], v[16:19], v[64:79]
    v_mfma_f32_32x32x16_bf16 v[64:79], v[28:31], v[24:27], v[64:79]

    s_mov_b64 exec, s[70:71]
    ds_read_b32 v28, v110 offset:64
    s_mov_b64 exec, s[72:73]
    ds_read_b32 v29, v110 offset:64
    s_mov_b64 exec, s[74:75]
    ds_read_b32 v30, v110 offset:64
    s_mov_b64 exec, s[76:77]
    ds_read_b32 v31, v110 offset:64
    s_mov_b64 exec, -1
    s_mov_b32 s60, 0
    s_lshr_b32 s54, s61, 2
    s_max_u32 s54, s54, 1
    s_lshr_b32 s44, s61, 1
    s_max_u32 s44, s44, 1
    s_cmp_lt_u32 s3, 8
    s_cselect_b32 s54, s54, s44
    s_mov_b32 s55, 0

    s_lshr_b32 s44, s61, 1
    s_lshl_b32 s57, 1, s44
    s_sub_u32 s45, s61, 2
    s_max_i32 s45, s45, 0
    s_lshl_b32 s46, 1, s45
    s_or_b32 s57, s57, s46
    s_sub_u32 s45, s61, 1
    s_max_i32 s45, s45, 0
    s_lshl_b32 s46, 1, s45
    s_or_b32 s57, s57, s46
    s_mov_b32 s56, 3
    s_setprio 3

    s_mov_b32 s67, 1
    s_bitcmp1_b32 s64, s67
    s_cbranch_scc0 k2_nob2_fs
    s_mov_b32 s44, 33
    v_readlane_b32 s65, v101, s67
    v_readlane_b32 s66, v101, s44
    s_nop 1
    v_mad_u32_u24 v108, v102, s65, v104
    v_mad_u32_u24 v109, v102, s66, v105
    ds_read_b64_tr_b16 v[24:25], v108
    ds_read_b64_tr_b16 v[26:27], v109

k2_nob2_fs:
    s_nop 4
    v_exp_f32 v32, v64
    v_exp_f32 v33, v65
    v_exp_f32 v34, v66
    v_exp_f32 v35, v67
    v_exp_f32 v36, v68
    v_exp_f32 v37, v69
    v_exp_f32 v38, v70
    v_exp_f32 v39, v71
    v_exp_f32 v40, v72
    v_exp_f32 v41, v73
    v_exp_f32 v42, v74
    v_exp_f32 v43, v75
    v_exp_f32 v44, v76
    v_exp_f32 v45, v77
    v_exp_f32 v46, v78
    v_exp_f32 v47, v79
    v_pk_add_f32 v[32:33], v[32:33], s[68:69]
    v_pk_add_f32 v[34:35], v[34:35], s[68:69]
    v_pk_add_f32 v[36:37], v[36:37], s[68:69]
    v_pk_add_f32 v[38:39], v[38:39], s[68:69]
    v_pk_add_f32 v[40:41], v[40:41], s[68:69]
    v_pk_add_f32 v[42:43], v[42:43], s[68:69]
    v_pk_add_f32 v[44:45], v[44:45], s[68:69]
    v_pk_add_f32 v[46:47], v[46:47], s[68:69]
    v_rcp_f32 v32, v32
    v_rcp_f32 v33, v33
    v_rcp_f32 v34, v34
    v_rcp_f32 v35, v35
    v_rcp_f32 v36, v36
    v_rcp_f32 v37, v37
    v_rcp_f32 v38, v38
    v_rcp_f32 v39, v39
    v_rcp_f32 v40, v40
    v_rcp_f32 v41, v41
    v_rcp_f32 v42, v42
    v_rcp_f32 v43, v43
    v_rcp_f32 v44, v44
    v_rcp_f32 v45, v45
    v_rcp_f32 v46, v46
    v_rcp_f32 v47, v47
    v_pk_fma_f32 v[8:9], v[64:65], v[32:33], v[8:9]
    v_pk_fma_f32 v[10:11], v[66:67], v[34:35], v[10:11]
    v_pk_fma_f32 v[8:9], v[68:69], v[36:37], v[8:9]
    v_pk_fma_f32 v[10:11], v[70:71], v[38:39], v[10:11]
    v_pk_fma_f32 v[8:9], v[72:73], v[40:41], v[8:9]
    v_pk_fma_f32 v[10:11], v[74:75], v[42:43], v[10:11]
    v_pk_fma_f32 v[8:9], v[76:77], v[44:45], v[8:9]
    v_pk_fma_f32 v[10:11], v[78:79], v[46:47], v[10:11]
    s_bitcmp1_b32 s64, s67
    s_cbranch_scc0 k2_nofl_fs

    s_bitcmp1_b32 s62, s67
    s_cselect_b32 exec_lo, -1, 0
    s_bitcmp1_b32 s63, s67
    s_cselect_b32 exec_hi, -1, 0
    ds_write_b32 v107, v8
    ds_write_b32 v107, v9 offset:128
    ds_write_b32 v107, v10 offset:256
    ds_write_b32 v107, v11 offset:384
    v_pk_fma_f32 v[2:3], v[8:9], v[8:9], v[2:3]
    v_pk_fma_f32 v[2:3], v[10:11], v[10:11], v[2:3]
    v_mad_u32_u24 v107, v102, s66, v106
    v_mad_u32_u24 v107, v103, s65, v107
    v_pk_mov_b32 v[8:9], 0, 0
    v_pk_mov_b32 v[10:11], 0, 0
    s_mov_b64 exec, -1

k2_nofl_fs:
    s_cmp_gt_u32 s61, 2
    s_cselect_b32 s38, 10001, 0
    buffer_load_dwordx4 v[48:51], v[4:5], s[36:39], 0 idxen offen
    buffer_load_dwordx4 v[52:55], v[4:5], s[36:39], 0 idxen offen offset:128
    s_mov_b32 s60, 1
    s_cmp_ge_u32 s60, s61
    s_cbranch_scc1 k2_main_dones
    s_waitcnt vmcnt(2) lgkmcnt(0)
    ds_read_b32 v4, v100 offset:256
    v_mfma_f32_32x32x16_bf16 v[80:95], v[56:59], v[20:23], 0
    v_mfma_f32_32x32x16_bf16 v[80:95], v[60:63], v[16:19], v[80:95]
    v_mfma_f32_32x32x16_bf16 v[80:95], v[28:31], v[24:27], v[80:95]

    s_mov_b64 exec, s[70:71]
    ds_read_b32 v28, v110 offset:128
    s_mov_b64 exec, s[72:73]
    ds_read_b32 v29, v110 offset:128
    s_mov_b64 exec, s[74:75]
    ds_read_b32 v30, v110 offset:128
    s_mov_b64 exec, s[76:77]
    ds_read_b32 v31, v110 offset:128
    s_mov_b64 exec, -1
    s_cmp_gt_u32 s61, 3
    s_cselect_b32 s38, 10001, 0
    buffer_load_dwordx4 v[56:59], v[6:7], s[36:39], 0 idxen offen
    buffer_load_dwordx4 v[60:63], v[6:7], s[36:39], 0 idxen offen offset:128
    s_branch k2_loop1s

k2_loops:
    s_add_u32 s67, s60, 1
    s_bitcmp1_b32 s64, s67
    s_cbranch_scc0 k2_nob2_0s
    s_add_u32 s44, s67, 32
    v_readlane_b32 s65, v101, s67
    v_readlane_b32 s66, v101, s44
    s_nop 1
    v_mad_u32_u24 v108, v102, s65, v104
    v_mad_u32_u24 v109, v102, s66, v105
    ds_read_b64_tr_b16 v[24:25], v108
    ds_read_b64_tr_b16 v[26:27], v109

k2_nob2_0s:
    s_waitcnt vmcnt(2) lgkmcnt(0)
    v_mfma_f32_32x32x16_bf16 v[80:95], v[56:59], v[20:23], 0

    v_exp_f32 v32, v64
    v_exp_f32 v33, v65
    v_exp_f32 v34, v66
    v_exp_f32 v35, v67
    v_exp_f32 v36, v68
    v_mfma_f32_32x32x16_bf16 v[80:95], v[60:63], v[16:19], v[80:95]
    v_exp_f32 v37, v69
    v_exp_f32 v38, v70
    v_exp_f32 v39, v71
    v_exp_f32 v40, v72
    v_exp_f32 v41, v73
    v_mfma_f32_32x32x16_bf16 v[80:95], v[28:31], v[24:27], v[80:95]
    s_add_u32 s44, s60, 3
    s_cmp_lt_u32 s44, s61
    s_cselect_b32 s38, 10001, 0
    buffer_load_dwordx4 v[56:59], v[6:7], s[36:39], 0 idxen offen
    buffer_load_dwordx4 v[60:63], v[6:7], s[36:39], 0 idxen offen offset:128
    ds_read_b32 v4, v100 offset:256

    s_mov_b64 exec, s[70:71]
    ds_read_b32 v28, v110 offset:128
    s_mov_b64 exec, s[72:73]
    ds_read_b32 v29, v110 offset:128
    s_mov_b64 exec, s[74:75]
    ds_read_b32 v30, v110 offset:128
    s_mov_b64 exec, s[76:77]
    ds_read_b32 v31, v110 offset:128
    s_mov_b64 exec, -1
    v_exp_f32 v42, v74
    v_exp_f32 v43, v75
    v_exp_f32 v44, v76
    v_exp_f32 v45, v77
    v_exp_f32 v46, v78
    v_exp_f32 v47, v79
    v_pk_add_f32 v[32:33], v[32:33], s[68:69]
    v_pk_add_f32 v[34:35], v[34:35], s[68:69]
    v_pk_add_f32 v[36:37], v[36:37], s[68:69]
    v_pk_add_f32 v[38:39], v[38:39], s[68:69]
    v_pk_add_f32 v[40:41], v[40:41], s[68:69]
    v_pk_add_f32 v[42:43], v[42:43], s[68:69]
    v_pk_add_f32 v[44:45], v[44:45], s[68:69]
    v_pk_add_f32 v[46:47], v[46:47], s[68:69]
    v_rcp_f32 v32, v32
    v_rcp_f32 v33, v33
    v_rcp_f32 v34, v34
    v_rcp_f32 v35, v35
    v_rcp_f32 v36, v36
    v_rcp_f32 v37, v37
    v_rcp_f32 v38, v38
    v_rcp_f32 v39, v39
    v_rcp_f32 v40, v40
    v_rcp_f32 v41, v41
    v_rcp_f32 v42, v42
    v_rcp_f32 v43, v43
    v_rcp_f32 v44, v44
    v_rcp_f32 v45, v45
    v_rcp_f32 v46, v46
    v_rcp_f32 v47, v47
    v_pk_fma_f32 v[8:9], v[64:65], v[32:33], v[8:9]
    v_pk_fma_f32 v[10:11], v[66:67], v[34:35], v[10:11]
    v_pk_fma_f32 v[8:9], v[68:69], v[36:37], v[8:9]
    v_pk_fma_f32 v[10:11], v[70:71], v[38:39], v[10:11]
    v_pk_fma_f32 v[8:9], v[72:73], v[40:41], v[8:9]
    v_pk_fma_f32 v[10:11], v[74:75], v[42:43], v[10:11]
    v_pk_fma_f32 v[8:9], v[76:77], v[44:45], v[8:9]
    v_pk_fma_f32 v[10:11], v[78:79], v[46:47], v[10:11]
    s_bitcmp1_b32 s64, s67
    s_cbranch_scc0 k2_nofl_0s

    s_bitcmp1_b32 s62, s67
    s_cselect_b32 exec_lo, -1, 0
    s_bitcmp1_b32 s63, s67
    s_cselect_b32 exec_hi, -1, 0
    ds_write_b32 v107, v8
    ds_write_b32 v107, v9 offset:128
    ds_write_b32 v107, v10 offset:256
    ds_write_b32 v107, v11 offset:384
    v_pk_fma_f32 v[2:3], v[8:9], v[8:9], v[2:3]
    v_pk_fma_f32 v[2:3], v[10:11], v[10:11], v[2:3]
    v_mad_u32_u24 v107, v102, s66, v106
    v_mad_u32_u24 v107, v103, s65, v107
    v_pk_mov_b32 v[8:9], 0, 0
    v_pk_mov_b32 v[10:11], 0, 0
    s_mov_b64 exec, -1

k2_nofl_0s:
    s_bitcmp1_b32 s57, s67
    s_cbranch_scc0 k2_nopr_0s
    s_sub_u32 s56, s56, 1
    s_setprio 0
    s_cmp_eq_u32 s56, 0
    s_cbranch_scc1 k2_nopr_0s
    s_setprio 1
    s_cmp_eq_u32 s56, 1
    s_cbranch_scc1 k2_nopr_0s
    s_setprio 2

k2_nopr_0s:
    s_mov_b32 s60, s67
    s_cmp_ge_u32 s60, s61

    s_cbranch_scc1 k2_main_dones
k2_loop1s:
    s_add_u32 s67, s60, 1
    s_bitcmp1_b32 s64, s67
    s_cbranch_scc0 k2_nob2_1s
    s_add_u32 s44, s67, 32
    v_readlane_b32 s65, v101, s67
    v_readlane_b32 s66, v101, s44
    s_nop 1
    v_mad_u32_u24 v108, v102, s65, v104
    v_mad_u32_u24 v109, v102, s66, v105
    ds_read_b64_tr_b16 v[24:25], v108
    ds_read_b64_tr_b16 v[26:27], v109

k2_nob2_1s:
    s_waitcnt vmcnt(2) lgkmcnt(0)
    v_mfma_f32_32x32x16_bf16 v[64:79], v[48:51], v[20:23], 0

    v_exp_f32 v32, v80
    v_exp_f32 v33, v81
    v_exp_f32 v34, v82
    v_exp_f32 v35, v83
    v_exp_f32 v36, v84
    v_mfma_f32_32x32x16_bf16 v[64:79], v[52:55], v[16:19], v[64:79]
    v_exp_f32 v37, v85
    v_exp_f32 v38, v86
    v_exp_f32 v39, v87
    v_exp_f32 v40, v88
    v_exp_f32 v41, v89
    v_mfma_f32_32x32x16_bf16 v[64:79], v[28:31], v[24:27], v[64:79]
    s_add_u32 s44, s60, 3
    s_cmp_lt_u32 s44, s61
    s_cselect_b32 s38, 10001, 0
    buffer_load_dwordx4 v[48:51], v[4:5], s[36:39], 0 idxen offen
    buffer_load_dwordx4 v[52:55], v[4:5], s[36:39], 0 idxen offen offset:128
    ds_read_b32 v6, v100 offset:320

    s_mov_b64 exec, s[70:71]
    ds_read_b32 v28, v110 offset:192
    s_mov_b64 exec, s[72:73]
    ds_read_b32 v29, v110 offset:192
    s_mov_b64 exec, s[74:75]
    ds_read_b32 v30, v110 offset:192
    s_mov_b64 exec, s[76:77]
    ds_read_b32 v31, v110 offset:192
    s_mov_b64 exec, -1
    v_exp_f32 v42, v90
    v_exp_f32 v43, v91
    v_exp_f32 v44, v92
    v_exp_f32 v45, v93
    v_exp_f32 v46, v94
    v_exp_f32 v47, v95
    v_pk_add_f32 v[32:33], v[32:33], s[68:69]
    v_pk_add_f32 v[34:35], v[34:35], s[68:69]
    v_pk_add_f32 v[36:37], v[36:37], s[68:69]
    v_pk_add_f32 v[38:39], v[38:39], s[68:69]
    v_pk_add_f32 v[40:41], v[40:41], s[68:69]
    v_pk_add_f32 v[42:43], v[42:43], s[68:69]
    v_pk_add_f32 v[44:45], v[44:45], s[68:69]
    v_pk_add_f32 v[46:47], v[46:47], s[68:69]
    v_rcp_f32 v32, v32
    v_rcp_f32 v33, v33
    v_rcp_f32 v34, v34
    v_rcp_f32 v35, v35
    v_rcp_f32 v36, v36
    v_rcp_f32 v37, v37
    v_rcp_f32 v38, v38
    v_rcp_f32 v39, v39
    v_rcp_f32 v40, v40
    v_rcp_f32 v41, v41
    v_rcp_f32 v42, v42
    v_rcp_f32 v43, v43
    v_rcp_f32 v44, v44
    v_rcp_f32 v45, v45
    v_rcp_f32 v46, v46
    v_rcp_f32 v47, v47
    v_pk_fma_f32 v[8:9], v[80:81], v[32:33], v[8:9]
    v_pk_fma_f32 v[10:11], v[82:83], v[34:35], v[10:11]
    v_pk_fma_f32 v[8:9], v[84:85], v[36:37], v[8:9]
    v_pk_fma_f32 v[10:11], v[86:87], v[38:39], v[10:11]
    v_pk_fma_f32 v[8:9], v[88:89], v[40:41], v[8:9]
    v_pk_fma_f32 v[10:11], v[90:91], v[42:43], v[10:11]
    v_pk_fma_f32 v[8:9], v[92:93], v[44:45], v[8:9]
    v_pk_fma_f32 v[10:11], v[94:95], v[46:47], v[10:11]
    s_bitcmp1_b32 s64, s67
    s_cbranch_scc0 k2_nofl_1s

    s_bitcmp1_b32 s62, s67
    s_cselect_b32 exec_lo, -1, 0
    s_bitcmp1_b32 s63, s67
    s_cselect_b32 exec_hi, -1, 0
    ds_write_b32 v107, v8
    ds_write_b32 v107, v9 offset:128
    ds_write_b32 v107, v10 offset:256
    ds_write_b32 v107, v11 offset:384
    v_pk_fma_f32 v[2:3], v[8:9], v[8:9], v[2:3]
    v_pk_fma_f32 v[2:3], v[10:11], v[10:11], v[2:3]
    v_mad_u32_u24 v107, v102, s66, v106
    v_mad_u32_u24 v107, v103, s65, v107
    v_pk_mov_b32 v[8:9], 0, 0
    v_pk_mov_b32 v[10:11], 0, 0
    s_mov_b64 exec, -1

k2_nofl_1s:
    s_bitcmp1_b32 s57, s67
    s_cbranch_scc0 k2_nopr_1s
    s_sub_u32 s56, s56, 1
    s_setprio 0
    s_cmp_eq_u32 s56, 0
    s_cbranch_scc1 k2_nopr_1s
    s_setprio 1
    s_cmp_eq_u32 s56, 1
    s_cbranch_scc1 k2_nopr_1s
    s_setprio 2

k2_nopr_1s:
    s_mov_b32 s60, s67
    s_cmp_ge_u32 s60, s61

    v_add_u32 v100, 128, v100
    v_add_u32 v110, 128, v110
    s_cbranch_scc0 k2_loops

k2_main_dones:
    v_mov_b32 v100, 54532

k2_hspins:
    ds_read_b32 v101, v100
    s_waitcnt lgkmcnt(0)
    v_readfirstlane_b32 s44, v101
    s_cmp_lt_u32 s44, 16
    s_cbranch_scc1 k2_hspins
    v_and_b32 v104, 31, v1
    v_lshlrev_b32 v104, 2, v104
    ds_read_b32 v100, v104 offset:54800
    v_lshlrev_b32 v101, 3, v1
    s_mul_i32 s44, s3, 800
    s_add_u32 s45, s44, 71424
    v_add_u32 v102, s45, v101
    v_add_u32 v101, 109824, v101
    v_lshrrev_b32 v103, 2, v1
    v_xor_b32 v103, s3, v103
    v_lshlrev_b32 v103, 4, v103
    v_and_b32 v104, 3, v1
    v_lshl_add_u32 v103, v104, 2, v103
    s_lshl_b32 s45, s3, 8
    s_add_u32 s45, s45, 59136
    v_add_u32 v103, s45, v103
    s_waitcnt lgkmcnt(0)

    s_add_u32 s45, s44, 0
    v_cmp_eq_u32 vcc, s45, v100
    s_mov_b32 s50, vcc_lo
    s_ff1_i32_b32 s46, s50
    s_cmp_eq_u32 s50, 0
    s_cselect_b32 s46, 32, s46
    s_bitset0_b32 s50, s46
    s_lshl_b32 s46, s46, 9
    v_add_u32 v104, s46, v101

    s_add_u32 s45, s44, 12800
    v_cmp_eq_u32 vcc, s45, v100
    s_mov_b32 s51, vcc_lo
    s_ff1_i32_b32 s46, s51
    s_cmp_eq_u32 s51, 0
    s_cselect_b32 s46, 32, s46
    s_bitset0_b32 s51, s46
    s_lshl_b32 s46, s46, 9
    v_add_u32 v105, s46, v101

    s_add_u32 s45, s44, 25600
    v_cmp_eq_u32 vcc, s45, v100
    s_mov_b32 s52, vcc_lo
    s_ff1_i32_b32 s46, s52
    s_cmp_eq_u32 s52, 0
    s_cselect_b32 s46, 32, s46
    s_bitset0_b32 s52, s46
    s_lshl_b32 s46, s46, 9
    v_add_u32 v106, s46, v101

    s_waitcnt vmcnt(0) lgkmcnt(0)
    s_barrier
k2_slow_sum:
    v_mov_b32 v100, 54532

k2_hspint:
    ds_read_b32 v101, v100
    s_waitcnt lgkmcnt(0)
    v_readfirstlane_b32 s44, v101
    s_cmp_lt_u32 s44, 16
    s_cbranch_scc1 k2_hspint
    v_and_b32 v104, 31, v1
    v_lshlrev_b32 v104, 2, v104
    ds_read_b32 v100, v104 offset:54800
    v_lshlrev_b32 v101, 3, v1
    s_mul_i32 s44, s3, 800
    s_add_u32 s45, s44, 71424
    v_add_u32 v102, s45, v101
    v_add_u32 v101, 109824, v101
    v_lshrrev_b32 v103, 2, v1
    v_xor_b32 v103, s3, v103
    v_lshlrev_b32 v103, 4, v103
    v_and_b32 v104, 3, v1
    v_lshl_add_u32 v103, v104, 2, v103
    s_lshl_b32 s45, s3, 8
    s_add_u32 s45, s45, 59136
    v_add_u32 v103, s45, v103
    s_waitcnt lgkmcnt(0)

    s_add_u32 s45, s44, 0
    v_cmp_eq_u32 vcc, s45, v100
    s_mov_b32 s50, vcc_lo
    s_ff1_i32_b32 s46, s50
    s_cmp_eq_u32 s50, 0
    s_cselect_b32 s46, 32, s46
    s_bitset0_b32 s50, s46
    s_lshl_b32 s46, s46, 9
    v_add_u32 v104, s46, v101

    s_add_u32 s45, s44, 12800
    v_cmp_eq_u32 vcc, s45, v100
    s_mov_b32 s51, vcc_lo
    s_ff1_i32_b32 s46, s51
    s_cmp_eq_u32 s51, 0
    s_cselect_b32 s46, 32, s46
    s_bitset0_b32 s51, s46
    s_lshl_b32 s46, s46, 9
    v_add_u32 v105, s46, v101

    s_add_u32 s45, s44, 25600
    v_cmp_eq_u32 vcc, s45, v100
    s_mov_b32 s52, vcc_lo
    s_ff1_i32_b32 s46, s52
    s_cmp_eq_u32 s52, 0
    s_cselect_b32 s46, 32, s46
    s_bitset0_b32 s52, s46
    s_lshl_b32 s46, s46, 9
    v_add_u32 v106, s46, v101

    ds_read_b64 v[36:37], v102
    ds_read_b64 v[42:43], v104
    ds_read_b64 v[38:39], v102 offset:12800
    ds_read_b64 v[44:45], v105
    ds_read_b64 v[40:41], v102 offset:25600
    ds_read_b64 v[46:47], v106

    s_waitcnt lgkmcnt(0)
    v_pk_add_f32 v[36:37], v[36:37], v[42:43]
    v_pk_add_f32 v[38:39], v[38:39], v[44:45]
    v_pk_add_f32 v[40:41], v[40:41], v[46:47]
k2_more0s:
    s_cmp_eq_u32 s50, 0
    s_cbranch_scc1 k2_nomore0s
    s_ff1_i32_b32 s46, s50
    s_bitset0_b32 s50, s46
    s_lshl_b32 s46, s46, 9
    v_add_u32 v35, s46, v101
    ds_read_b64 v[42:43], v35
    s_waitcnt lgkmcnt(0)
    v_pk_add_f32 v[36:37], v[36:37], v[42:43]
    s_branch k2_more0s

k2_nomore0s:
k2_more1s:
    s_cmp_eq_u32 s51, 0
    s_cbranch_scc1 k2_nomore1s
    s_ff1_i32_b32 s46, s51
    s_bitset0_b32 s51, s46
    s_lshl_b32 s46, s46, 9
    v_add_u32 v35, s46, v101
    ds_read_b64 v[42:43], v35
    s_waitcnt lgkmcnt(0)
    v_pk_add_f32 v[38:39], v[38:39], v[42:43]
    s_branch k2_more1s

k2_nomore1s:
k2_more2s:
    s_cmp_eq_u32 s52, 0
    s_cbranch_scc1 k2_nomore2s
    s_ff1_i32_b32 s46, s52
    s_bitset0_b32 s52, s46
    s_lshl_b32 s46, s46, 9
    v_add_u32 v35, s46, v101
    ds_read_b64 v[42:43], v35
    s_waitcnt lgkmcnt(0)
    v_pk_add_f32 v[40:41], v[40:41], v[42:43]
    s_branch k2_more2s

k2_nomore2s:
    v_mov_b32 v120, v36
    v_mov_b32 v121, v37
    v_mov_b32 v122, v38
    v_mov_b32 v123, v39
    v_mov_b32 v124, v40
    v_mov_b32 v125, v41
    s_bitcmp1_b32 s84, 1
    s_cbranch_scc0 k2_slow_fin
    s_mov_b32 s85, 0
    s_mov_b32 s86, 0
k2_ov_loop:
    s_lshl_b32 s44, s85, 2
    s_add_u32 s44, s44, 6881280
    s_add_u32 s46, s20, s44
    s_addc_u32 s47, s21, 0
    s_load_dword s87, s[46:47], 0
    s_waitcnt lgkmcnt(0)
    s_cmp_lt_u32 s86, s87
    s_cbranch_scc1 k2_ov_pass
    s_add_u32 s85, s85, 1
    s_mov_b32 s86, 0
    s_cmp_lt_u32 s85, 100
    s_cbranch_scc1 k2_ov_loop
    s_branch k2_slow_fin

k2_ov_pass:
    s_waitcnt vmcnt(0) lgkmcnt(0)
    s_barrier
    v_lshlrev_b32 v2, 2, v1
    v_mov_b32 v8, 0
    v_writelane_b32 v8, 8, 62
    v_add_u32 v4, -512, v0
    v_lshlrev_b32 v6, 2, v4
    v_lshlrev_b32 v3, 4, v0
    s_cmp_eq_u32 s3, 0
    s_cbranch_scc0 k2_ov_nz
    ds_write_b32 v2, v8 offset:54288

k2_ov_nz:
    v_lshrrev_b32 v102, 5, v1
    v_and_b32 v108, 3, v1
    v_lshlrev_b32 v5, 6, v102
    v_lshl_add_u32 v5, v108, 4, v5
    v_mov_b32 v7, v5
    v_bfe_u32 v106, v1, 2, 1
    v_lshlrev_b32 v106, 6, v106
    v_bfe_u32 v110, v1, 4, 1
    v_lshl_add_u32 v106, v110, 5, v106
    v_bfe_u32 v111, v1, 3, 1
    v_lshl_add_u32 v106, v111, 4, v106
    v_lshl_add_u32 v106, v108, 2, v106
    v_add_u32 v106, 71424, v106

    v_mov_b32 v108, 0x3f800000
    v_mov_b32 v109, 0x3f80
    s_mov_b32 s44, 0xaaaaaaaa
    s_mov_b32 s45, 0xaaaaaaaa
    v_cndmask_b32 v111, v109, v108, s[44:45]

    s_mov_b32 s44, 0x3
    s_mov_b32 s45, 0x300
    v_cndmask_b32 v20, 0, v111, s[44:45]
    s_mov_b32 s44, 0x30000
    s_mov_b32 s45, 0x3000000
    v_cndmask_b32 v16, 0, v111, s[44:45]
    s_mov_b32 s44, 0xc
    s_mov_b32 s45, 0xc00
    v_cndmask_b32 v21, 0, v111, s[44:45]
    s_mov_b32 s44, 0xc0000
    s_mov_b32 s45, 0xc000000
    v_cndmask_b32 v17, 0, v111, s[44:45]
    s_mov_b32 s44, 0x30
    s_mov_b32 s45, 0x3000
    v_cndmask_b32 v22, 0, v111, s[44:45]
    s_mov_b32 s44, 0x300000
    s_mov_b32 s45, 0x30000000
    v_cndmask_b32 v18, 0, v111, s[44:45]
    s_mov_b32 s44, 0xc0
    s_mov_b32 s45, 0xc000
    v_cndmask_b32 v23, 0, v111, s[44:45]
    s_mov_b32 s44, 0xc00000
    s_mov_b32 s45, 0xc0000000
    v_cndmask_b32 v19, 0, v111, s[44:45]
    v_sub_u32 v103, 1, v102
    v_and_b32 v109, 1, v1
    v_lshlrev_b32 v109, 5, v109
    v_bfe_u32 v110, v1, 4, 1
    v_lshl_add_u32 v109, v110, 4, v109
    v_bfe_u32 v111, v1, 1, 1
    v_lshl_add_u32 v109, v111, 3, v109
    v_bfe_u32 v111, v1, 2, 2
    v_and_b32 v104, 1, v111
    v_lshlrev_b32 v104, 8, v104
    v_lshrrev_b32 v105, 1, v111
    v_lshl_add_u32 v104, v105, 6, v104
    v_add_u32 v104, 55040, v104
    v_lshlrev_b32 v105, 6, v111
    v_add_u32 v105, 71952, v105
    s_mov_b32 s44, 0
    s_mov_b32 s45, -1
    v_cndmask_b32 v104, v104, v105, s[44:45]
    v_add_u32 v104, v104, v109
    v_lshl_add_u32 v105, v103, 7, v104
    s_mov_b32 s68, 1.0
    s_mov_b32 s69, 1.0

    s_cmp_lt_u32 s3, 8
    s_cbranch_scc1 k2_ov_g1
    v_lshlrev_b32 v108, 2, v6
    v_mov_b32 v110, 0x3f80
    v_mov_b32 v111, 1.0

    ds_write_b64 v108, v[110:111] offset:8
    ds_write_b64 v108, v[110:111] offset:8200
    ds_write_b64 v108, v[110:111] offset:16392
    ds_write_b64 v108, v[110:111] offset:24584
    ds_write_b64 v108, v[110:111] offset:32776
    ds_write_b64 v108, v[110:111] offset:40968
    v_cmp_gt_u32 vcc, 320, v4
    s_mov_b64 exec, vcc
    ds_write_b64 v108, v[110:111] offset:49160
    s_mov_b64 exec, -1
    v_mov_b32 v64, 0
    v_mov_b32 v65, 0
    v_mov_b32 v66, 0
    v_mov_b32 v67, 0
    v_lshrrev_b32 v96, 5, v4
    v_mov_b32 v97, 800
    v_mul_u32_u24 v96, v96, v97
    v_and_b32 v97, 31, v4
    v_lshl_add_u32 v96, v97, 4, v96
    v_add_u32 v96, 71424, v96
    ds_write_b128 v96, v[64:67]
    ds_write_b128 v96, v[64:67] offset:12800
    ds_write_b128 v96, v[64:67] offset:25600
    s_cmp_eq_u32 s3, 14
    s_cbranch_scc0 k2_s_nozro
    v_lshlrev_b32 v96, 3, v1
    v_add_u32 v96, 126208, v96
    ds_write_b64 v96, v[64:65]

k2_s_nozro:
k2_ov_g1:
    s_waitcnt lgkmcnt(0)
    s_barrier
    s_cmp_lt_u32 s3, 8
    s_cbranch_scc1 k2_ov_g2

    s_mul_i32 s44, s85, 25600
    s_add_u32 s44, s44, 8388608
    s_add_u32 s24, s20, s44
    s_addc_u32 s25, s21, 0
    s_and_b32 s25, s25, 0xffff
    s_lshl_b32 s26, s87, 3
    s_mov_b32 s27, 0x20000
    v_add_u32 v24, s86, v4
    v_lshlrev_b32 v25, 3, v24

    s_mov_b32 s44, 0
    buffer_load_dwordx2 v[64:65], v25, s[24:27], s44 offen
    s_mov_b32 s44, 4096
    buffer_load_dwordx2 v[66:67], v25, s[24:27], s44 offen
    s_mov_b32 s44, 8192
    buffer_load_dwordx2 v[68:69], v25, s[24:27], s44 offen
    s_mov_b32 s44, 12288
    buffer_load_dwordx2 v[70:71], v25, s[24:27], s44 offen
    s_mov_b32 s44, 16384
    buffer_load_dwordx2 v[72:73], v25, s[24:27], s44 offen
    s_mov_b32 s44, 20480
    buffer_load_dwordx2 v[74:75], v25, s[24:27], s44 offen
    s_waitcnt vmcnt(0)
    v_mul_u32_u24 v26, 429497, v64
    v_lshrrev_b32 v26, 24, v26
    v_cmp_eq_u32 vcc, s2, v26
    v_add_u32 v27, 0, v24
    v_cmp_gt_u32 s[44:45], s87, v27
    s_and_b64 vcc, vcc, s[44:45]
    v_subrev_u32 v27, s22, v64
    v_add_u32 v27, 1, v27
    v_cndmask_b32 v32, 0, v27, vcc
    v_mov_b32 v40, v65

    v_mul_u32_u24 v26, 429497, v66
    v_lshrrev_b32 v26, 24, v26
    v_cmp_eq_u32 vcc, s2, v26
    v_add_u32 v27, 512, v24
    v_cmp_gt_u32 s[44:45], s87, v27
    s_and_b64 vcc, vcc, s[44:45]
    v_subrev_u32 v27, s22, v66
    v_add_u32 v27, 1, v27
    v_cndmask_b32 v33, 0, v27, vcc
    v_mov_b32 v41, v67

    v_mul_u32_u24 v26, 429497, v68
    v_lshrrev_b32 v26, 24, v26
    v_cmp_eq_u32 vcc, s2, v26
    v_add_u32 v27, 1024, v24
    v_cmp_gt_u32 s[44:45], s87, v27
    s_and_b64 vcc, vcc, s[44:45]
    v_subrev_u32 v27, s22, v68
    v_add_u32 v27, 1, v27
    v_cndmask_b32 v34, 0, v27, vcc
    v_mov_b32 v42, v69

    v_mul_u32_u24 v26, 429497, v70
    v_lshrrev_b32 v26, 24, v26
    v_cmp_eq_u32 vcc, s2, v26
    v_add_u32 v27, 1536, v24
    v_cmp_gt_u32 s[44:45], s87, v27
    s_and_b64 vcc, vcc, s[44:45]
    v_subrev_u32 v27, s22, v70
    v_add_u32 v27, 1, v27
    v_cndmask_b32 v35, 0, v27, vcc
    v_mov_b32 v43, v71

    v_mul_u32_u24 v26, 429497, v72
    v_lshrrev_b32 v26, 24, v26
    v_cmp_eq_u32 vcc, s2, v26
    v_add_u32 v27, 2048, v24
    v_cmp_gt_u32 s[44:45], s87, v27
    s_and_b64 vcc, vcc, s[44:45]
    v_subrev_u32 v27, s22, v72
    v_add_u32 v27, 1, v27
    v_cndmask_b32 v36, 0, v27, vcc
    v_mov_b32 v44, v73

    v_mul_u32_u24 v26, 429497, v74
    v_lshrrev_b32 v26, 24, v26
    v_cmp_eq_u32 vcc, s2, v26
    v_add_u32 v27, 2560, v24
    v_cmp_gt_u32 s[44:45], s87, v27
    s_and_b64 vcc, vcc, s[44:45]
    v_subrev_u32 v27, s22, v74
    v_add_u32 v27, 1, v27
    v_cndmask_b32 v37, 0, v27, vcc
    v_mov_b32 v45, v75

    v_mov_b32 v38, 0
    v_mov_b32 v46, 0
    v_mov_b32 v28, 1

    v_mov_b32 v84, 10000
    v_mov_b32 v85, 0
    v_mov_b32 v86, 0
    v_mov_b32 v87, 0
    v_mov_b32 v31, 800
    v_mul_u32_u24 v31, v1, v31
    v_mov_b32 v29, 54540
    s_sub_u32 s46, s3, 8

    v_cmp_ne_u32 s[70:71], 0, v32
    v_lshlrev_b32 v48, 2, v32
    v_cmp_ne_u32 s[72:73], 0, v33
    v_lshlrev_b32 v49, 2, v33
    v_cmp_ne_u32 s[74:75], 0, v34
    v_lshlrev_b32 v50, 2, v34
    v_cmp_ne_u32 s[76:77], 0, v35
    v_lshlrev_b32 v51, 2, v35
    v_cmp_ne_u32 s[78:79], 0, v36
    v_lshlrev_b32 v52, 2, v36
    v_cmp_ne_u32 s[80:81], 0, v37
    v_lshlrev_b32 v53, 2, v37
    v_cmp_ne_u32 s[82:83], 0, v38
    v_lshlrev_b32 v54, 2, v38
    s_mov_b64 exec, s[70:71]
    ds_add_rtn_u32 v56, v48, v28 offset:54284
    s_mov_b64 exec, s[72:73]
    ds_add_rtn_u32 v57, v49, v28 offset:54284
    s_mov_b64 exec, s[74:75]
    ds_add_rtn_u32 v58, v50, v28 offset:54284
    s_mov_b64 exec, s[76:77]
    ds_add_rtn_u32 v59, v51, v28 offset:54284
    s_mov_b64 exec, s[78:79]
    ds_add_rtn_u32 v60, v52, v28 offset:54284
    s_mov_b64 exec, s[80:81]
    ds_add_rtn_u32 v61, v53, v28 offset:54284
    s_mov_b64 exec, s[82:83]
    ds_add_rtn_u32 v62, v54, v28 offset:54284
    s_mov_b64 exec, -1
    s_waitcnt vmcnt(0)
    s_mov_b32 s44, 0x03020302
    v_and_b32 v64, 0xffff, v40
    v_perm_b32 v65, v40, v40, s44
    v_and_b32 v66, 0xffff, v41
    v_perm_b32 v67, v41, v41, s44
    v_and_b32 v68, 0xffff, v42
    v_perm_b32 v69, v42, v42, s44
    v_and_b32 v70, 0xffff, v43
    v_perm_b32 v71, v43, v43, s44
    v_and_b32 v72, 0xffff, v44
    v_perm_b32 v73, v44, v44, s44
    v_and_b32 v74, 0xffff, v45
    v_perm_b32 v75, v45, v45, s44
    v_and_b32 v76, 0xffff, v46
    v_perm_b32 v77, v46, v46, s44
    s_waitcnt lgkmcnt(0)
    s_mov_b64 exec, 1
    ds_add_u32 v29, v28
    s_mov_b64 exec, -1

k2_spino:
    ds_read_b32 v24, v2 offset:54288
    s_waitcnt lgkmcnt(0)
    v_readlane_b32 s44, v24, 63
    s_cmp_lt_u32 s44, 8
    s_cbranch_scc1 k2_spino

    v_add_u32 v25, 3, v24
    v_and_b32 v25, -4, v25
    s_mov_b32 s44, -1
    s_mov_b32 s45, 0xffff
    v_cndmask_b32 v25, 0, v25, s[44:45]
    v_cndmask_b32 v24, 0, v24, s[44:45]
    v_mov_b32 v26, v25
    s_nop 1

    v_add_u32_dpp v26, v26, v26 row_shr:1 row_mask:0xf bank_mask:0xf bound_ctrl:0
    s_nop 1
    v_add_u32_dpp v26, v26, v26 row_shr:2 row_mask:0xf bank_mask:0xf bound_ctrl:0
    s_nop 1
    v_add_u32_dpp v26, v26, v26 row_shr:4 row_mask:0xf bank_mask:0xf bound_ctrl:0
    s_nop 1
    v_add_u32_dpp v26, v26, v26 row_shr:8 row_mask:0xf bank_mask:0xf bound_ctrl:0
    s_nop 1
    v_add_u32_dpp v26, v26, v26 row_bcast:15 row_mask:0xa bank_mask:0xf
    s_nop 1
    v_add_u32_dpp v26, v26, v26 row_bcast:31 row_mask:0xc bank_mask:0xf
    v_sub_u32 v27, v26, v25
    v_lshlrev_b32 v28, 4, v27
    ds_write_b32 v2, v28 offset:54544
    v_readlane_b32 s60, v26, 63
    v_add_u32 v28, s46, v24
    v_cmp_lt_u32 vcc, v28, v25
    v_add_lshl_u32 v28, v28, v27, 4
    s_lshl_b32 s44, s46, 2
    v_add_u32 v29, s44, v27
    v_add_u32 v30, v27, v25
    s_mov_b32 s58, s60
    s_mov_b64 s[54:55], vcc
    s_mov_b32 s53, s46

    s_lshr_b32 s60, s60, 2
    s_add_u32 s60, s60, 1
    s_lshr_b32 s60, s60, 1
    s_cmp_gt_u32 s60, 8
    s_cselect_b32 s46, 4, 0
    s_sub_u32 s47, s60, s46
    s_mul_i32 s44, s3, s47
    s_add_u32 s45, s44, s47
    s_lshl_b32 s46, s46, 1
    s_sub_i32 s48, s3, 8
    s_max_i32 s48, s48, 0
    s_mul_i32 s48, s48, s46
    s_add_u32 s44, s44, s48
    s_sub_i32 s48, s3, 7
    s_max_i32 s48, s48, 0
    s_mul_i32 s48, s48, s46
    s_add_u32 s45, s45, s48
    s_lshr_b32 s44, s44, 4
    s_lshr_b32 s45, s45, 4
    s_sub_u32 s61, s45, s44
    s_lshl_b32 s59, s44, 1
    v_and_b32 v109, 31, v1
    v_mul_u32_u24 v101, s61, v102
    v_add3_u32 v101, v101, v109, s59
    v_lshlrev_b32 v101, 2, v101
    v_add_u32 v108, -4, v101
    v_max_i32 v108, 0, v108
    v_bfe_u32 v109, v1, 2, 1
    v_mul_u32_u24 v100, s61, v109
    v_add_u32 v100, s59, v100
    v_bfe_u32 v109, v1, 3, 2
    v_lshl_add_u32 v100, v100, 2, v109
    v_lshlrev_b32 v100, 4, v100
    v_and_b32 v109, 1, v1
    v_lshl_add_u32 v109, v109, 2, 4
    v_mad_u32_u24 v110, v109, v102, v100
    v_add_u32 v110, 4, v110
    s_lshl_b32 s45, s3, 10
    s_add_u32 s45, s45, 38400
    v_lshl_add_u32 v107, v102, 9, v106
    v_add_u32 v107, s45, v107

    s_waitcnt lgkmcnt(0)
    ds_read_b32 v32, v48 offset:54540
    ds_read_b32 v33, v49 offset:54540
    ds_read_b32 v34, v50 offset:54540
    ds_read_b32 v35, v51 offset:54540
    ds_read_b32 v36, v52 offset:54540
    ds_read_b32 v37, v53 offset:54540
    ds_read_b32 v38, v54 offset:54540
    s_cmp_lt_u32 s53, 3
    s_cbranch_scc0 k2_nopado
    s_mov_b64 exec, s[54:55]
    ds_write_b128 v28, v[84:87]
    s_mov_b64 exec, -1

k2_nopado:
k2_subn_loopo:
    v_cmp_lt_u32 vcc, v29, v30
    s_and_b64 exec, exec, vcc
    s_cbranch_execz k2_subn_doneo
    ds_write_b32 v29, v31 offset:55552
    v_add_u32 v29, 32, v29
    s_branch k2_subn_loopo

k2_subn_doneo:
    s_mov_b64 exec, -1
    s_cmp_eq_u32 s53, 3
    s_cbranch_scc0 k2_nodummyo
    s_mov_b64 exec, 15
    v_add_u32 v24, s58, v1
    v_lshlrev_b32 v24, 4, v24
    v_mov_b32 v25, s58
    v_mov_b32 v26, 37600
    v_mov_b32 v27, 54928
    ds_write_b128 v24, v[84:87]
    ds_write_b32 v25, v26 offset:55552
    ds_write_b32 v27, v25

k2_nodummyo:
    s_waitcnt lgkmcnt(0)
    s_mov_b64 exec, s[70:71]
    v_lshl_add_u32 v32, v56, 4, v32
    ds_write_b64 v32, v[64:65]

    s_mov_b64 exec, s[72:73]
    v_lshl_add_u32 v33, v57, 4, v33
    ds_write_b64 v33, v[66:67]

    s_mov_b64 exec, s[74:75]
    v_lshl_add_u32 v34, v58, 4, v34
    ds_write_b64 v34, v[68:69]

    s_mov_b64 exec, s[76:77]
    v_lshl_add_u32 v35, v59, 4, v35
    ds_write_b64 v35, v[70:71]

    s_mov_b64 exec, s[78:79]
    v_lshl_add_u32 v36, v60, 4, v36
    ds_write_b64 v36, v[72:73]

    s_mov_b64 exec, s[80:81]
    v_lshl_add_u32 v37, v61, 4, v37
    ds_write_b64 v37, v[74:75]

    s_cmp_eq_u64 s[82:83], 0
    s_cbranch_scc1 k2_nos6o

    s_mov_b64 exec, s[82:83]
    v_lshl_add_u32 v38, v62, 4, v38
    ds_write_b64 v38, v[76:77]

k2_nos6o:
    s_mov_b64 exec, -1
    s_waitcnt lgkmcnt(0)
    s_barrier
    s_branch k2_ov_main

k2_ov_g2:
    s_barrier
    v_mov_b32 v24, 54928
    ds_read_b32 v24, v24
    s_waitcnt lgkmcnt(0)
    v_readfirstlane_b32 s60, v24

    s_lshr_b32 s60, s60, 2
    s_add_u32 s60, s60, 1
    s_lshr_b32 s60, s60, 1
    s_cmp_gt_u32 s60, 8
    s_cselect_b32 s46, 4, 0
    s_sub_u32 s47, s60, s46
    s_mul_i32 s44, s3, s47
    s_add_u32 s45, s44, s47
    s_lshl_b32 s46, s46, 1
    s_sub_i32 s48, s3, 8
    s_max_i32 s48, s48, 0
    s_mul_i32 s48, s48, s46
    s_add_u32 s44, s44, s48
    s_sub_i32 s48, s3, 7
    s_max_i32 s48, s48, 0
    s_mul_i32 s48, s48, s46
    s_add_u32 s45, s45, s48
    s_lshr_b32 s44, s44, 4
    s_lshr_b32 s45, s45, 4
    s_sub_u32 s61, s45, s44
    s_lshl_b32 s59, s44, 1
    v_and_b32 v109, 31, v1
    v_mul_u32_u24 v101, s61, v102
    v_add3_u32 v101, v101, v109, s59
    v_lshlrev_b32 v101, 2, v101
    v_add_u32 v108, -4, v101
    v_max_i32 v108, 0, v108
    v_bfe_u32 v109, v1, 2, 1
    v_mul_u32_u24 v100, s61, v109
    v_add_u32 v100, s59, v100
    v_bfe_u32 v109, v1, 3, 2
    v_lshl_add_u32 v100, v100, 2, v109
    v_lshlrev_b32 v100, 4, v100
    v_and_b32 v109, 1, v1
    v_lshl_add_u32 v109, v109, 2, 4
    v_mad_u32_u24 v110, v109, v102, v100
    v_add_u32 v110, 4, v110
    s_lshl_b32 s45, s3, 10
    s_add_u32 s45, s45, 38400
    v_lshl_add_u32 v107, v102, 9, v106
    v_add_u32 v107, s45, v107

k2_ov_main:
    ds_read_b32 v4, v100
    ds_read_b32 v109, v101 offset:55552
    ds_read_b32 v108, v108 offset:55552
    ds_read_b32 v6, v100 offset:64
    v_mov_b32 v28, 0
    v_mov_b32 v29, 0
    v_mov_b32 v30, 0
    v_mov_b32 v31, 0

    s_mov_b32 s70, 0x11111111
    s_mov_b32 s71, 0x3030303
    s_mov_b32 s72, 0x22222222
    s_mov_b32 s73, 0xc0c0c0c
    s_mov_b32 s74, 0x44444444
    s_mov_b32 s75, 0x30303030
    s_mov_b32 s76, 0x88888888
    s_mov_b32 s77, 0xc0c0c0c0
    s_mov_b64 exec, s[70:71]
    ds_read_b32 v28, v110 offset:0
    s_mov_b64 exec, s[72:73]
    ds_read_b32 v29, v110 offset:0
    s_mov_b64 exec, s[74:75]
    ds_read_b32 v30, v110 offset:0
    s_mov_b64 exec, s[76:77]
    ds_read_b32 v31, v110 offset:0
    s_mov_b64 exec, -1
    s_mov_b32 s36, s20
    s_and_b32 s37, s21, 0xffff
    s_or_b32 s37, s37, 16777216
    s_mov_b32 s38, 10001
    s_mov_b32 s39, 0x20000
    s_mov_b32 s49, 0
    s_cmp_gt_u32 s61, 0
    s_cselect_b32 s38, 10001, 0
    s_waitcnt lgkmcnt(7)
    buffer_load_dwordx4 v[48:51], v[4:5], s[36:39], 0 idxen offen
    buffer_load_dwordx4 v[52:55], v[4:5], s[36:39], 0 idxen offen offset:128

    s_waitcnt lgkmcnt(4)
    v_mov_b32 v101, v109
    v_cmp_ne_u32 vcc, v108, v109
    ds_read_b32 v4, v100 offset:128
    s_lshl_b32 s45, s3, 3
    v_lshl_add_u32 v111, v102, 2, s45
    v_mov_b32 v108, v101
    s_mov_b32 s62, vcc_lo
    s_mov_b32 s63, vcc_hi
    s_cmp_eq_u32 s61, 0
    s_cbranch_scc0 k2_hno
    v_mov_b32 v108, -1

k2_hno:
    s_mov_b32 exec_lo, 1
    s_mov_b32 exec_hi, 1
    ds_write_b32 v111, v108 offset:54800
    s_mov_b32 exec_hi, 0
    v_mov_b32 v108, 54532
    v_mov_b32 v109, 1
    ds_add_u32 v108, v109
    s_mov_b64 exec, -1
    s_lshl_b32 s44, 1, s61
    s_or_b32 s62, s62, s44
    s_or_b32 s63, s63, s44
    s_or_b32 s64, s62, s63
    s_mov_b32 s44, 32
    v_readlane_b32 s65, v101, 0
    v_readlane_b32 s66, v101, s44
    v_mov_b32 v111, 54536

k2_qspino:
    ds_read_b32 v108, v111
    s_waitcnt lgkmcnt(0)
    v_readfirstlane_b32 s44, v108
    s_cmp_lt_u32 s44, 8
    s_cbranch_scc1 k2_qspino
    s_cmp_gt_u32 s61, 1
    s_cselect_b32 s38, 10001, 0
    v_mad_u32_u24 v108, v102, s65, v104
    v_mad_u32_u24 v109, v102, s66, v105
    ds_read_b64_tr_b16 v[24:25], v108
    ds_read_b64_tr_b16 v[26:27], v109
    buffer_load_dwordx4 v[56:59], v[6:7], s[36:39], 0 idxen offen
    buffer_load_dwordx4 v[60:63], v[6:7], s[36:39], 0 idxen offen offset:128
    ds_read_b32 v6, v100 offset:192
    v_mov_b32 v8, 0
    v_mov_b32 v9, 0
    v_mov_b32 v10, 0
    v_mov_b32 v11, 0
    v_mov_b32 v2, 0
    v_mov_b32 v3, 0
    s_cmp_eq_u32 s61, 0
    s_cbranch_scc1 k2_main_doneo
    s_waitcnt lgkmcnt(0)
    s_waitcnt vmcnt(2)

    v_mfma_f32_32x32x16_bf16 v[64:79], v[48:51], v[20:23], 0
    v_mfma_f32_32x32x16_bf16 v[64:79], v[52:55], v[16:19], v[64:79]
    v_mfma_f32_32x32x16_bf16 v[64:79], v[28:31], v[24:27], v[64:79]

    s_mov_b64 exec, s[70:71]
    ds_read_b32 v28, v110 offset:64
    s_mov_b64 exec, s[72:73]
    ds_read_b32 v29, v110 offset:64
    s_mov_b64 exec, s[74:75]
    ds_read_b32 v30, v110 offset:64
    s_mov_b64 exec, s[76:77]
    ds_read_b32 v31, v110 offset:64
    s_mov_b64 exec, -1
    s_mov_b32 s60, 0
    s_lshr_b32 s54, s61, 2
    s_max_u32 s54, s54, 1
    s_lshr_b32 s44, s61, 1
    s_max_u32 s44, s44, 1
    s_cmp_lt_u32 s3, 8
    s_cselect_b32 s54, s54, s44
    s_mov_b32 s55, 0

    s_lshr_b32 s44, s61, 1
    s_lshl_b32 s57, 1, s44
    s_sub_u32 s45, s61, 2
    s_max_i32 s45, s45, 0
    s_lshl_b32 s46, 1, s45
    s_or_b32 s57, s57, s46
    s_sub_u32 s45, s61, 1
    s_max_i32 s45, s45, 0
    s_lshl_b32 s46, 1, s45
    s_or_b32 s57, s57, s46
    s_mov_b32 s56, 3
    s_setprio 3

    s_mov_b32 s67, 1
    s_bitcmp1_b32 s64, s67
    s_cbranch_scc0 k2_nob2_fo
    s_mov_b32 s44, 33
    v_readlane_b32 s65, v101, s67
    v_readlane_b32 s66, v101, s44
    s_nop 1
    v_mad_u32_u24 v108, v102, s65, v104
    v_mad_u32_u24 v109, v102, s66, v105
    ds_read_b64_tr_b16 v[24:25], v108
    ds_read_b64_tr_b16 v[26:27], v109

k2_nob2_fo:
    s_nop 4
    v_exp_f32 v32, v64
    v_exp_f32 v33, v65
    v_exp_f32 v34, v66
    v_exp_f32 v35, v67
    v_exp_f32 v36, v68
    v_exp_f32 v37, v69
    v_exp_f32 v38, v70
    v_exp_f32 v39, v71
    v_exp_f32 v40, v72
    v_exp_f32 v41, v73
    v_exp_f32 v42, v74
    v_exp_f32 v43, v75
    v_exp_f32 v44, v76
    v_exp_f32 v45, v77
    v_exp_f32 v46, v78
    v_exp_f32 v47, v79
    v_pk_add_f32 v[32:33], v[32:33], s[68:69]
    v_pk_add_f32 v[34:35], v[34:35], s[68:69]
    v_pk_add_f32 v[36:37], v[36:37], s[68:69]
    v_pk_add_f32 v[38:39], v[38:39], s[68:69]
    v_pk_add_f32 v[40:41], v[40:41], s[68:69]
    v_pk_add_f32 v[42:43], v[42:43], s[68:69]
    v_pk_add_f32 v[44:45], v[44:45], s[68:69]
    v_pk_add_f32 v[46:47], v[46:47], s[68:69]
    v_rcp_f32 v32, v32
    v_rcp_f32 v33, v33
    v_rcp_f32 v34, v34
    v_rcp_f32 v35, v35
    v_rcp_f32 v36, v36
    v_rcp_f32 v37, v37
    v_rcp_f32 v38, v38
    v_rcp_f32 v39, v39
    v_rcp_f32 v40, v40
    v_rcp_f32 v41, v41
    v_rcp_f32 v42, v42
    v_rcp_f32 v43, v43
    v_rcp_f32 v44, v44
    v_rcp_f32 v45, v45
    v_rcp_f32 v46, v46
    v_rcp_f32 v47, v47
    v_pk_fma_f32 v[8:9], v[64:65], v[32:33], v[8:9]
    v_pk_fma_f32 v[10:11], v[66:67], v[34:35], v[10:11]
    v_pk_fma_f32 v[8:9], v[68:69], v[36:37], v[8:9]
    v_pk_fma_f32 v[10:11], v[70:71], v[38:39], v[10:11]
    v_pk_fma_f32 v[8:9], v[72:73], v[40:41], v[8:9]
    v_pk_fma_f32 v[10:11], v[74:75], v[42:43], v[10:11]
    v_pk_fma_f32 v[8:9], v[76:77], v[44:45], v[8:9]
    v_pk_fma_f32 v[10:11], v[78:79], v[46:47], v[10:11]
    s_bitcmp1_b32 s64, s67
    s_cbranch_scc0 k2_nofl_fo

    s_bitcmp1_b32 s62, s67
    s_cselect_b32 exec_lo, -1, 0
    s_bitcmp1_b32 s63, s67
    s_cselect_b32 exec_hi, -1, 0
    ds_write_b32 v107, v8
    ds_write_b32 v107, v9 offset:128
    ds_write_b32 v107, v10 offset:256
    ds_write_b32 v107, v11 offset:384
    v_pk_fma_f32 v[2:3], v[8:9], v[8:9], v[2:3]
    v_pk_fma_f32 v[2:3], v[10:11], v[10:11], v[2:3]
    v_mad_u32_u24 v107, v102, s66, v106
    v_mad_u32_u24 v107, v103, s65, v107
    v_pk_mov_b32 v[8:9], 0, 0
    v_pk_mov_b32 v[10:11], 0, 0
    s_mov_b64 exec, -1

k2_nofl_fo:
    s_cmp_gt_u32 s61, 2
    s_cselect_b32 s38, 10001, 0
    buffer_load_dwordx4 v[48:51], v[4:5], s[36:39], 0 idxen offen
    buffer_load_dwordx4 v[52:55], v[4:5], s[36:39], 0 idxen offen offset:128
    s_mov_b32 s60, 1
    s_cmp_ge_u32 s60, s61
    s_cbranch_scc1 k2_main_doneo
    s_waitcnt vmcnt(2) lgkmcnt(0)
    ds_read_b32 v4, v100 offset:256
    v_mfma_f32_32x32x16_bf16 v[80:95], v[56:59], v[20:23], 0
    v_mfma_f32_32x32x16_bf16 v[80:95], v[60:63], v[16:19], v[80:95]
    v_mfma_f32_32x32x16_bf16 v[80:95], v[28:31], v[24:27], v[80:95]

    s_mov_b64 exec, s[70:71]
    ds_read_b32 v28, v110 offset:128
    s_mov_b64 exec, s[72:73]
    ds_read_b32 v29, v110 offset:128
    s_mov_b64 exec, s[74:75]
    ds_read_b32 v30, v110 offset:128
    s_mov_b64 exec, s[76:77]
    ds_read_b32 v31, v110 offset:128
    s_mov_b64 exec, -1
    s_cmp_gt_u32 s61, 3
    s_cselect_b32 s38, 10001, 0
    buffer_load_dwordx4 v[56:59], v[6:7], s[36:39], 0 idxen offen
    buffer_load_dwordx4 v[60:63], v[6:7], s[36:39], 0 idxen offen offset:128
    s_branch k2_loop1o

k2_loopo:
    s_add_u32 s67, s60, 1
    s_bitcmp1_b32 s64, s67
    s_cbranch_scc0 k2_nob2_0o
    s_add_u32 s44, s67, 32
    v_readlane_b32 s65, v101, s67
    v_readlane_b32 s66, v101, s44
    s_nop 1
    v_mad_u32_u24 v108, v102, s65, v104
    v_mad_u32_u24 v109, v102, s66, v105
    ds_read_b64_tr_b16 v[24:25], v108
    ds_read_b64_tr_b16 v[26:27], v109

k2_nob2_0o:
    s_waitcnt vmcnt(2) lgkmcnt(0)
    v_mfma_f32_32x32x16_bf16 v[80:95], v[56:59], v[20:23], 0

    v_exp_f32 v32, v64
    v_exp_f32 v33, v65
    v_exp_f32 v34, v66
    v_exp_f32 v35, v67
    v_exp_f32 v36, v68
    v_mfma_f32_32x32x16_bf16 v[80:95], v[60:63], v[16:19], v[80:95]
    v_exp_f32 v37, v69
    v_exp_f32 v38, v70
    v_exp_f32 v39, v71
    v_exp_f32 v40, v72
    v_exp_f32 v41, v73
    v_mfma_f32_32x32x16_bf16 v[80:95], v[28:31], v[24:27], v[80:95]
    s_add_u32 s44, s60, 3
    s_cmp_lt_u32 s44, s61
    s_cselect_b32 s38, 10001, 0
    buffer_load_dwordx4 v[56:59], v[6:7], s[36:39], 0 idxen offen
    buffer_load_dwordx4 v[60:63], v[6:7], s[36:39], 0 idxen offen offset:128
    ds_read_b32 v4, v100 offset:256

    s_mov_b64 exec, s[70:71]
    ds_read_b32 v28, v110 offset:128
    s_mov_b64 exec, s[72:73]
    ds_read_b32 v29, v110 offset:128
    s_mov_b64 exec, s[74:75]
    ds_read_b32 v30, v110 offset:128
    s_mov_b64 exec, s[76:77]
    ds_read_b32 v31, v110 offset:128
    s_mov_b64 exec, -1
    v_exp_f32 v42, v74
    v_exp_f32 v43, v75
    v_exp_f32 v44, v76
    v_exp_f32 v45, v77
    v_exp_f32 v46, v78
    v_exp_f32 v47, v79
    v_pk_add_f32 v[32:33], v[32:33], s[68:69]
    v_pk_add_f32 v[34:35], v[34:35], s[68:69]
    v_pk_add_f32 v[36:37], v[36:37], s[68:69]
    v_pk_add_f32 v[38:39], v[38:39], s[68:69]
    v_pk_add_f32 v[40:41], v[40:41], s[68:69]
    v_pk_add_f32 v[42:43], v[42:43], s[68:69]
    v_pk_add_f32 v[44:45], v[44:45], s[68:69]
    v_pk_add_f32 v[46:47], v[46:47], s[68:69]
    v_rcp_f32 v32, v32
    v_rcp_f32 v33, v33
    v_rcp_f32 v34, v34
    v_rcp_f32 v35, v35
    v_rcp_f32 v36, v36
    v_rcp_f32 v37, v37
    v_rcp_f32 v38, v38
    v_rcp_f32 v39, v39
    v_rcp_f32 v40, v40
    v_rcp_f32 v41, v41
    v_rcp_f32 v42, v42
    v_rcp_f32 v43, v43
    v_rcp_f32 v44, v44
    v_rcp_f32 v45, v45
    v_rcp_f32 v46, v46
    v_rcp_f32 v47, v47
    v_pk_fma_f32 v[8:9], v[64:65], v[32:33], v[8:9]
    v_pk_fma_f32 v[10:11], v[66:67], v[34:35], v[10:11]
    v_pk_fma_f32 v[8:9], v[68:69], v[36:37], v[8:9]
    v_pk_fma_f32 v[10:11], v[70:71], v[38:39], v[10:11]
    v_pk_fma_f32 v[8:9], v[72:73], v[40:41], v[8:9]
    v_pk_fma_f32 v[10:11], v[74:75], v[42:43], v[10:11]
    v_pk_fma_f32 v[8:9], v[76:77], v[44:45], v[8:9]
    v_pk_fma_f32 v[10:11], v[78:79], v[46:47], v[10:11]
    s_bitcmp1_b32 s64, s67
    s_cbranch_scc0 k2_nofl_0o

    s_bitcmp1_b32 s62, s67
    s_cselect_b32 exec_lo, -1, 0
    s_bitcmp1_b32 s63, s67
    s_cselect_b32 exec_hi, -1, 0
    ds_write_b32 v107, v8
    ds_write_b32 v107, v9 offset:128
    ds_write_b32 v107, v10 offset:256
    ds_write_b32 v107, v11 offset:384
    v_pk_fma_f32 v[2:3], v[8:9], v[8:9], v[2:3]
    v_pk_fma_f32 v[2:3], v[10:11], v[10:11], v[2:3]
    v_mad_u32_u24 v107, v102, s66, v106
    v_mad_u32_u24 v107, v103, s65, v107
    v_pk_mov_b32 v[8:9], 0, 0
    v_pk_mov_b32 v[10:11], 0, 0
    s_mov_b64 exec, -1

k2_nofl_0o:
    s_bitcmp1_b32 s57, s67
    s_cbranch_scc0 k2_nopr_0o
    s_sub_u32 s56, s56, 1
    s_setprio 0
    s_cmp_eq_u32 s56, 0
    s_cbranch_scc1 k2_nopr_0o
    s_setprio 1
    s_cmp_eq_u32 s56, 1
    s_cbranch_scc1 k2_nopr_0o
    s_setprio 2

k2_nopr_0o:
    s_mov_b32 s60, s67
    s_cmp_ge_u32 s60, s61

    s_cbranch_scc1 k2_main_doneo
k2_loop1o:
    s_add_u32 s67, s60, 1
    s_bitcmp1_b32 s64, s67
    s_cbranch_scc0 k2_nob2_1o
    s_add_u32 s44, s67, 32
    v_readlane_b32 s65, v101, s67
    v_readlane_b32 s66, v101, s44
    s_nop 1
    v_mad_u32_u24 v108, v102, s65, v104
    v_mad_u32_u24 v109, v102, s66, v105
    ds_read_b64_tr_b16 v[24:25], v108
    ds_read_b64_tr_b16 v[26:27], v109

k2_nob2_1o:
    s_waitcnt vmcnt(2) lgkmcnt(0)
    v_mfma_f32_32x32x16_bf16 v[64:79], v[48:51], v[20:23], 0

    v_exp_f32 v32, v80
    v_exp_f32 v33, v81
    v_exp_f32 v34, v82
    v_exp_f32 v35, v83
    v_exp_f32 v36, v84
    v_mfma_f32_32x32x16_bf16 v[64:79], v[52:55], v[16:19], v[64:79]
    v_exp_f32 v37, v85
    v_exp_f32 v38, v86
    v_exp_f32 v39, v87
    v_exp_f32 v40, v88
    v_exp_f32 v41, v89
    v_mfma_f32_32x32x16_bf16 v[64:79], v[28:31], v[24:27], v[64:79]
    s_add_u32 s44, s60, 3
    s_cmp_lt_u32 s44, s61
    s_cselect_b32 s38, 10001, 0
    buffer_load_dwordx4 v[48:51], v[4:5], s[36:39], 0 idxen offen
    buffer_load_dwordx4 v[52:55], v[4:5], s[36:39], 0 idxen offen offset:128
    ds_read_b32 v6, v100 offset:320

    s_mov_b64 exec, s[70:71]
    ds_read_b32 v28, v110 offset:192
    s_mov_b64 exec, s[72:73]
    ds_read_b32 v29, v110 offset:192
    s_mov_b64 exec, s[74:75]
    ds_read_b32 v30, v110 offset:192
    s_mov_b64 exec, s[76:77]
    ds_read_b32 v31, v110 offset:192
    s_mov_b64 exec, -1
    v_exp_f32 v42, v90
    v_exp_f32 v43, v91
    v_exp_f32 v44, v92
    v_exp_f32 v45, v93
    v_exp_f32 v46, v94
    v_exp_f32 v47, v95
    v_pk_add_f32 v[32:33], v[32:33], s[68:69]
    v_pk_add_f32 v[34:35], v[34:35], s[68:69]
    v_pk_add_f32 v[36:37], v[36:37], s[68:69]
    v_pk_add_f32 v[38:39], v[38:39], s[68:69]
    v_pk_add_f32 v[40:41], v[40:41], s[68:69]
    v_pk_add_f32 v[42:43], v[42:43], s[68:69]
    v_pk_add_f32 v[44:45], v[44:45], s[68:69]
    v_pk_add_f32 v[46:47], v[46:47], s[68:69]
    v_rcp_f32 v32, v32
    v_rcp_f32 v33, v33
    v_rcp_f32 v34, v34
    v_rcp_f32 v35, v35
    v_rcp_f32 v36, v36
    v_rcp_f32 v37, v37
    v_rcp_f32 v38, v38
    v_rcp_f32 v39, v39
    v_rcp_f32 v40, v40
    v_rcp_f32 v41, v41
    v_rcp_f32 v42, v42
    v_rcp_f32 v43, v43
    v_rcp_f32 v44, v44
    v_rcp_f32 v45, v45
    v_rcp_f32 v46, v46
    v_rcp_f32 v47, v47
    v_pk_fma_f32 v[8:9], v[80:81], v[32:33], v[8:9]
    v_pk_fma_f32 v[10:11], v[82:83], v[34:35], v[10:11]
    v_pk_fma_f32 v[8:9], v[84:85], v[36:37], v[8:9]
    v_pk_fma_f32 v[10:11], v[86:87], v[38:39], v[10:11]
    v_pk_fma_f32 v[8:9], v[88:89], v[40:41], v[8:9]
    v_pk_fma_f32 v[10:11], v[90:91], v[42:43], v[10:11]
    v_pk_fma_f32 v[8:9], v[92:93], v[44:45], v[8:9]
    v_pk_fma_f32 v[10:11], v[94:95], v[46:47], v[10:11]
    s_bitcmp1_b32 s64, s67
    s_cbranch_scc0 k2_nofl_1o

    s_bitcmp1_b32 s62, s67
    s_cselect_b32 exec_lo, -1, 0
    s_bitcmp1_b32 s63, s67
    s_cselect_b32 exec_hi, -1, 0
    ds_write_b32 v107, v8
    ds_write_b32 v107, v9 offset:128
    ds_write_b32 v107, v10 offset:256
    ds_write_b32 v107, v11 offset:384
    v_pk_fma_f32 v[2:3], v[8:9], v[8:9], v[2:3]
    v_pk_fma_f32 v[2:3], v[10:11], v[10:11], v[2:3]
    v_mad_u32_u24 v107, v102, s66, v106
    v_mad_u32_u24 v107, v103, s65, v107
    v_pk_mov_b32 v[8:9], 0, 0
    v_pk_mov_b32 v[10:11], 0, 0
    s_mov_b64 exec, -1

k2_nofl_1o:
    s_bitcmp1_b32 s57, s67
    s_cbranch_scc0 k2_nopr_1o
    s_sub_u32 s56, s56, 1
    s_setprio 0
    s_cmp_eq_u32 s56, 0
    s_cbranch_scc1 k2_nopr_1o
    s_setprio 1
    s_cmp_eq_u32 s56, 1
    s_cbranch_scc1 k2_nopr_1o
    s_setprio 2

k2_nopr_1o:
    s_mov_b32 s60, s67
    s_cmp_ge_u32 s60, s61

    v_add_u32 v100, 128, v100
    v_add_u32 v110, 128, v110
    s_cbranch_scc0 k2_loopo

k2_main_doneo:
    v_mov_b32 v100, 54532

k2_hspino:
    ds_read_b32 v101, v100
    s_waitcnt lgkmcnt(0)
    v_readfirstlane_b32 s44, v101
    s_cmp_lt_u32 s44, 16
    s_cbranch_scc1 k2_hspino
    v_and_b32 v104, 31, v1
    v_lshlrev_b32 v104, 2, v104
    ds_read_b32 v100, v104 offset:54800
    v_lshlrev_b32 v101, 3, v1
    s_mul_i32 s44, s3, 800
    s_add_u32 s45, s44, 71424
    v_add_u32 v102, s45, v101
    v_add_u32 v101, 109824, v101
    v_lshrrev_b32 v103, 2, v1
    v_xor_b32 v103, s3, v103
    v_lshlrev_b32 v103, 4, v103
    v_and_b32 v104, 3, v1
    v_lshl_add_u32 v103, v104, 2, v103
    s_lshl_b32 s45, s3, 8
    s_add_u32 s45, s45, 59136
    v_add_u32 v103, s45, v103
    s_waitcnt lgkmcnt(0)

    s_add_u32 s45, s44, 0
    v_cmp_eq_u32 vcc, s45, v100
    s_mov_b32 s50, vcc_lo
    s_ff1_i32_b32 s46, s50
    s_cmp_eq_u32 s50, 0
    s_cselect_b32 s46, 32, s46
    s_bitset0_b32 s50, s46
    s_lshl_b32 s46, s46, 9
    v_add_u32 v104, s46, v101

    s_add_u32 s45, s44, 12800
    v_cmp_eq_u32 vcc, s45, v100
    s_mov_b32 s51, vcc_lo
    s_ff1_i32_b32 s46, s51
    s_cmp_eq_u32 s51, 0
    s_cselect_b32 s46, 32, s46
    s_bitset0_b32 s51, s46
    s_lshl_b32 s46, s46, 9
    v_add_u32 v105, s46, v101

    s_add_u32 s45, s44, 25600
    v_cmp_eq_u32 vcc, s45, v100
    s_mov_b32 s52, vcc_lo
    s_ff1_i32_b32 s46, s52
    s_cmp_eq_u32 s52, 0
    s_cselect_b32 s46, 32, s46
    s_bitset0_b32 s52, s46
    s_lshl_b32 s46, s46, 9
    v_add_u32 v106, s46, v101

    s_waitcnt vmcnt(0) lgkmcnt(0)
    s_barrier
    ds_read_b64 v[36:37], v102
    ds_read_b64 v[42:43], v104
    ds_read_b64 v[38:39], v102 offset:12800
    ds_read_b64 v[44:45], v105
    ds_read_b64 v[40:41], v102 offset:25600
    ds_read_b64 v[46:47], v106

    s_waitcnt lgkmcnt(0)
    v_pk_add_f32 v[36:37], v[36:37], v[42:43]
    v_pk_add_f32 v[38:39], v[38:39], v[44:45]
    v_pk_add_f32 v[40:41], v[40:41], v[46:47]
k2_more0o:
    s_cmp_eq_u32 s50, 0
    s_cbranch_scc1 k2_nomore0o
    s_ff1_i32_b32 s46, s50
    s_bitset0_b32 s50, s46
    s_lshl_b32 s46, s46, 9
    v_add_u32 v35, s46, v101
    ds_read_b64 v[42:43], v35
    s_waitcnt lgkmcnt(0)
    v_pk_add_f32 v[36:37], v[36:37], v[42:43]
    s_branch k2_more0o

k2_nomore0o:
k2_more1o:
    s_cmp_eq_u32 s51, 0
    s_cbranch_scc1 k2_nomore1o
    s_ff1_i32_b32 s46, s51
    s_bitset0_b32 s51, s46
    s_lshl_b32 s46, s46, 9
    v_add_u32 v35, s46, v101
    ds_read_b64 v[42:43], v35
    s_waitcnt lgkmcnt(0)
    v_pk_add_f32 v[38:39], v[38:39], v[42:43]
    s_branch k2_more1o

k2_nomore1o:
k2_more2o:
    s_cmp_eq_u32 s52, 0
    s_cbranch_scc1 k2_nomore2o
    s_ff1_i32_b32 s46, s52
    s_bitset0_b32 s52, s46
    s_lshl_b32 s46, s46, 9
    v_add_u32 v35, s46, v101
    ds_read_b64 v[42:43], v35
    s_waitcnt lgkmcnt(0)
    v_pk_add_f32 v[40:41], v[40:41], v[42:43]
    s_branch k2_more2o

k2_nomore2o:
    v_pk_add_f32 v[120:121], v[120:121], v[36:37]
    v_pk_add_f32 v[122:123], v[122:123], v[38:39]
    v_pk_add_f32 v[124:125], v[124:125], v[40:41]
    s_add_u32 s86, s86, 3072
    s_branch k2_ov_loop

k2_slow_fin:
    v_mov_b32 v108, v120
    v_mov_b32 v109, v121
    v_mov_b32 v110, v122
    v_mov_b32 v111, v123
    v_mov_b32 v112, v124
    v_mov_b32 v113, v125
    s_mov_b32 s40, s16
    s_and_b32 s41, s17, 0xffff
    s_mov_b32 s42, 2560000
    s_mov_b32 s43, 0x20000
    s_cmp_lt_u32 s3, 8
    s_cbranch_scc0 k2_slow_f2
    s_mov_b32 s49, 0
    s_add_u32 s32, s20, 2621440
    s_addc_u32 s33, s21, 0
    s_and_b32 s33, s33, 0xffff
    s_mov_b32 s34, 98304
    s_mov_b32 s35, 0x20000
    v_lshlrev_b32 v5, 4, v1
    s_cmp_eq_u32 s49, 0
    s_cbranch_scc0 k2_dma_okz
    s_lshl_b32 s44, s3, 12
    s_add_u32 s45, s44, 65536
    s_add_u32 s44, s44, 126720
    s_mov_b32 m0, s44
    s_nop 0

    buffer_load_dwordx4 v5, s[32:35], s45 offen offset:0 lds
    buffer_load_dwordx4 v5, s[32:35], s45 offen offset:1024 lds
    buffer_load_dwordx4 v5, s[32:35], s45 offen offset:2048 lds
    buffer_load_dwordx4 v5, s[32:35], s45 offen offset:3072 lds
k2_dma_okz:
    s_waitcnt vmcnt(0)
    s_add_u32 s44, s3, 8
    s_lshl_b32 s44, s44, 12

    buffer_load_dwordx4 v[80:83], v5, s[32:35], s44 offen offset:0
    buffer_load_dwordx4 v[84:87], v5, s[32:35], s44 offen offset:1024
    buffer_load_dwordx4 v[88:91], v5, s[32:35], s44 offen offset:2048
    buffer_load_dwordx4 v[92:95], v5, s[32:35], s44 offen offset:3072
    s_lshl_b32 s44, s3, 12
    s_add_u32 s44, s44, 126720
    v_add_u32 v5, s44, v5
    ds_read_b128 v[16:19], v5
    ds_read_b128 v[20:23], v5 offset:1024
    ds_read_b128 v[24:27], v5 offset:2048
    ds_read_b128 v[28:31], v5 offset:3072
    v_and_b32 v6, 15, v1
    v_lshrrev_b32 v7, 4, v1
    v_xor_b32 v8, v7, v6
    v_lshlrev_b32 v8, 4, v8
    v_lshl_add_u32 v8, v6, 8, v8
    v_add_u32 v8, 59136, v8
    v_xor_b32 v9, 64, v8
    v_xor_b32 v10, 0x80, v8
    v_xor_b32 v11, 0xc0, v8

    ds_read_b128 v[32:35], v8 offset:0
    ds_read_b128 v[36:39], v9 offset:0
    ds_read_b128 v[40:43], v10 offset:0
    ds_read_b128 v[44:47], v11 offset:0
    ds_read_b128 v[48:51], v8 offset:4096
    ds_read_b128 v[52:55], v9 offset:4096
    ds_read_b128 v[56:59], v10 offset:4096
    ds_read_b128 v[60:63], v11 offset:4096
    ds_read_b128 v[64:67], v8 offset:8192
    ds_read_b128 v[68:71], v9 offset:8192
    ds_read_b128 v[72:75], v10 offset:8192
    ds_read_b128 v[76:79], v11 offset:8192
    v_add_u32 v2, s22, v6
    v_lshlrev_b32 v2, 8, v2
    v_lshl_add_u32 v2, v7, 3, v2
    s_lshl_b32 s44, s3, 5
    v_add_u32 v2, s44, v2
    v_add_u32 v3, 32, v6
    s_waitcnt vmcnt(0) lgkmcnt(0)

    v_mfma_f32_16x16x32_bf16 v[116:119], v[80:83], v[32:35], 0
    v_mfma_f32_16x16x32_bf16 v[116:119], v[84:87], v[36:39], v[116:119]
    v_mfma_f32_16x16x32_bf16 v[116:119], v[88:91], v[40:43], v[116:119]
    v_mfma_f32_16x16x32_bf16 v[116:119], v[92:95], v[44:47], v[116:119]
    v_mfma_f32_16x16x32_bf16 v[120:123], v[80:83], v[48:51], 0
    v_mfma_f32_16x16x32_bf16 v[120:123], v[84:87], v[52:55], v[120:123]
    v_mfma_f32_16x16x32_bf16 v[120:123], v[88:91], v[56:59], v[120:123]
    v_mfma_f32_16x16x32_bf16 v[120:123], v[92:95], v[60:63], v[120:123]
    v_mfma_f32_16x16x32_bf16 v[124:127], v[80:83], v[64:67], 0
    v_mfma_f32_16x16x32_bf16 v[124:127], v[84:87], v[68:71], v[124:127]
    v_mfma_f32_16x16x32_bf16 v[124:127], v[88:91], v[72:75], v[124:127]
    v_mfma_f32_16x16x32_bf16 v[124:127], v[92:95], v[76:79], v[124:127]
k2_slow_f2:
    s_waitcnt vmcnt(0) lgkmcnt(0)
    s_barrier
    v_mov_b32 v36, v108
    v_mov_b32 v37, v109
    v_mov_b32 v38, v110
    v_mov_b32 v39, v111
    v_mov_b32 v40, v112
    v_mov_b32 v41, v113
    s_mov_b32 s56, 0xbf317218
    s_mov_b32 s57, 0xbf317218
    s_branch k2_cvt

k2_end:
    s_endpgm
.section .rodata,"a"
.p2align 6
.amdhsa_kernel mpnn_prep_kernel
  .amdhsa_next_free_vgpr 64
  .amdhsa_next_free_sgpr 64
  .amdhsa_accum_offset 64
  .amdhsa_group_segment_fixed_size 0
  .amdhsa_kernarg_size 72
  .amdhsa_user_sgpr_count 2
  .amdhsa_user_sgpr_kernarg_segment_ptr 1
  .amdhsa_system_sgpr_workgroup_id_x 1
  .amdhsa_float_denorm_mode_32 3
.end_amdhsa_kernel
.p2align 6
.amdhsa_kernel mpnn_edge_kernel
  .amdhsa_next_free_vgpr 128
  .amdhsa_next_free_sgpr 96
  .amdhsa_accum_offset 128
  .amdhsa_group_segment_fixed_size 0
  .amdhsa_kernarg_size 72
  .amdhsa_user_sgpr_count 2
  .amdhsa_user_sgpr_kernarg_segment_ptr 1
  .amdhsa_system_sgpr_workgroup_id_x 1
  .amdhsa_float_denorm_mode_32 3
.end_amdhsa_kernel
```
